```python
import torch

def _softmax(x, axis=-1):
    return torch.softmax(x, dim=axis)

def _gelu(x):
    return torch.nn.functional.gelu(x, approximate='tanh')

def _silu(x):
    return torch.nn.functional.silu(x)

def _sigmoid(x):
    return torch.sigmoid(x)

def _layernorm(x, axis=-1, eps=1e-05):
    m = x.mean(dim=axis, keepdim=True)
    v = x.var(dim=axis, keepdim=True, unbiased=False)
    return (x - m) / torch.sqrt(v + eps)

def _scatter_add(tgt, idx, src, axis=0):
    return tgt.clone().index_add_(axis, idx, src)

def _segment_sum(src, seg, n):
    out = torch.zeros((n,) + src.shape[1:], dtype=src.dtype)
    return out.index_add_(0, seg, src)

def _pad(x, pw):
    flat = tuple((v for pair in reversed(pw) for v in pair))
    return torch.nn.functional.pad(x, flat)
kernel_name = 'standalone__autoregressive_conv_wavernn__speech'

def setup_inputs():

    _w = lambda a: (lambda t: t.to(torch.bfloat16) if t.is_floating_point() else t)(torch.as_tensor(a))
    B, T, D, K = (2, 4000, 512, 5)
    return {'x': _w((lambda *s: torch.randn(*s, dtype=torch.bfloat16) * 0.05)(B, T, D)), 'w': _w((lambda *s: torch.randn(*s, dtype=torch.bfloat16) * 0.05)(K, D, 2 * D))}

def reference(x, w):
    B, T, D = x.shape
    K = w.shape[0]
    dil = 2
    pad = (K - 1) * dil
    xp = _pad(x, ((0, 0), (pad, 0), (0, 0)))
    h = torch.einsum('btd,de->bte', xp[:, 0:T, :], w[0])
    for i in range(1, K):
        h = h + torch.einsum('btd,de->bte', xp[:, i * dil:i * dil + T, :], w[i])
    f, g = (h[..., :D].clone(), h[..., D:].clone())
    return torch.tanh(f) * _sigmoid(g)
```

```asm
; @launch grid=(256,1,1) block=(256,1,1) lds=163840
.amdgcn_target "amdgcn-amd-amdhsa--gfx950"
.text
.globl standalone__autoregressive_conv_wavernn__speech_kernel
.p2align 8
.type standalone__autoregressive_conv_wavernn__speech_kernel,@function
standalone__autoregressive_conv_wavernn__speech_kernel:

    s_cmp_ge_u32 s2, 256
    s_cbranch_scc1 L_end
    s_load_dwordx4 s[36:39], s[0:1], 0
    s_load_dwordx2 s[40:41], s[0:1], 16
    s_and_b32 s42, s2, 7
    s_lshr_b32 s43, s2, 3
    s_lshr_b32 s44, s42, 1
    s_lshl_b32 s44, s44, 3
    s_lshr_b32 s73, s43, 2
    s_and_b32 s74, s43, 3
    s_mov_b32 s43, s74
    s_add_u32 s44, s44, s73
    s_and_b32 s42, s42, 1
    s_lshl_b32 s42, s42, 2
    s_add_u32 s42, s42, s43
    s_lshr_b32 s43, s44, 4
    s_lshr_b32 s45, s44, 1
    s_and_b32 s45, s45, 7
    s_and_b32 s44, s44, 1
    s_mul_i32 s45, s45, 500
    s_add_u32 s45, s45, s44
    s_sub_u32 s45, s45, 8
    s_lshl_b32 s45, s45, 10
    s_mul_i32 s43, s43, 4096000
    s_lshl_b32 s42, s42, 7
    v_and_b32 v1, 63, v0
    v_lshrrev_b32 v24, 6, v0
    s_nop 0
    v_readfirstlane_b32 s16, v24
    v_lshrrev_b32 v60, 2, v1
    v_mul_u32_u24 v61, 13, v60
    v_lshrrev_b32 v61, 6, v61
    v_mul_u32_u24 v62, 5, v61
    v_sub_u32 v60, v60, v62
    v_lshlrev_b32 v60, 20, v60
    v_lshlrev_b32 v61, 16, v61
    v_add_u32 v60, v60, v61
    v_and_b32 v61, 3, v1
    v_lshlrev_b32 v61, 14, v61
    v_add_u32 v60, v60, v61
    s_lshl_b32 s75, s73, 11
    s_add_u32 s75, s75, s42
    s_and_b32 s76, s16, 1
    s_lshl_b32 s77, s76, 10
    s_add_u32 s75, s75, s77
    v_add_u32 v60, s75, v60
    v_add_u32 v63, 131072, v60
    s_cmp_lt_u32 s16, 2
    s_cselect_b32 s77, 60, 0
    v_mov_b32 v62, 0x80000000
    v_cmp_gt_u32 vcc, s77, v1
    s_nop 1
    v_cndmask_b32 v60, v62, v60, vcc
    v_lshrrev_b32 v24, 3, v1
    v_lshrrev_b32 v25, 4, v1
    v_and_b32 v26, 7, v1
    v_xor_b32 v25, v25, v26
    v_xor_b32 v26, 4, v25
    v_lshlrev_b32 v25, 4, v25
    v_lshlrev_b32 v26, 4, v26
    v_lshlrev_b32 v24, 15, v24
    s_lshl_b32 s46, s16, 13
    s_add_u32 s46, s46, s45
    v_add_u32 v24, s46, v24
    v_add_u32 v64, v24, v25
    v_add_u32 v68, v24, v26
    v_add_u32 v68, 0x40000, v68
    v_add_u32 v65, 1024, v64
    v_add_u32 v69, 1024, v68
    v_add_u32 v66, 2048, v64
    v_add_u32 v70, 2048, v68
    v_add_u32 v67, 3072, v64
    v_add_u32 v71, 3072, v68
    v_lshrrev_b32 v24, 4, v1
    s_and_b32 s46, s16, 1
    s_lshl_b32 s46, s46, 2
    v_or_b32 v25, s46, v24
    v_bfe_u32 v26, v1, 1, 3
    v_xor_b32 v25, v25, v26
    v_and_b32 v26, 3, v25
    v_lshlrev_b32 v26, 5, v26
    v_lshrrev_b32 v25, 2, v25
    v_lshlrev_b32 v25, 10, v25
    v_add_u32 v25, v25, v26
    v_and_b32 v26, 1, v1
    v_lshlrev_b32 v26, 4, v26
    v_add_u32 v25, v25, v26
    v_lshlrev_b32 v24, 11, v24
    v_add_u32 v25, v25, v24
    s_lshl_b32 s46, s16, 14
    s_add_u32 s46, s46, s42
    v_add_u32 v6, s46, v25
    s_mov_b32 s20, 0
    s_mov_b32 s21, 7168
    s_mov_b32 s22, 1046528
    s_mov_b32 s23, 1053696
    s_mov_b32 s24, 2097152
    s_mov_b32 s25, 2104320
    s_mov_b32 s26, 3143680
    s_mov_b32 s27, 3150848
    s_mov_b32 s28, 4194304
    s_mov_b32 s29, 4201472
    s_lshl_b32 s30, s16, 12
    s_mul_i32 s31, s16, 10240
    s_add_u32 s31, s31, 81920
    s_mov_b32 s17, 0
    s_waitcnt lgkmcnt(0)
    s_add_u32 s4, s36, s43
    s_addc_u32 s5, s37, 0
    s_and_b32 s5, s5, 0xffff
    s_mov_b32 s6, 4096000
    s_mov_b32 s7, 0x20000
    s_mov_b32 s8, s38
    s_and_b32 s9, s39, 0xffff
    s_mov_b32 s10, 5242880
    s_mov_b32 s11, 0x20000
    s_mov_b32 s64, s8
    s_mov_b32 s65, s9
    s_mov_b32 s66, 5242880
    s_mov_b32 s67, 0x20000
    s_cmp_eq_u32 s42, 384
    s_cbranch_scc0 L_noft
    buffer_load_dword v23, v60, s[64:67], 0 offen
L_noft:
    s_add_u32 m0, s30, 0
    s_nop 0
    buffer_load_dwordx4 v64, s[4:7], s17 offen lds
    buffer_load_dwordx4 v65, s[4:7], s17 offen offset:1024 lds
    buffer_load_dwordx4 v66, s[4:7], s17 offen offset:2048 lds
    buffer_load_dwordx4 v67, s[4:7], s17 offen offset:3072 lds
    s_add_u32 m0, s30, 16384
    s_nop 0
    buffer_load_dwordx4 v68, s[4:7], s17 offen lds
    buffer_load_dwordx4 v69, s[4:7], s17 offen offset:1024 lds
    buffer_load_dwordx4 v70, s[4:7], s17 offen offset:2048 lds
    buffer_load_dwordx4 v71, s[4:7], s17 offen offset:3072 lds
    s_add_u32 s17, s17, 128
    s_add_u32 s12, s40, s43
    s_addc_u32 s13, s41, 0
    s_and_b32 s13, s13, 0xffff
    s_mov_b32 s14, 4096000
    s_mov_b32 s15, 0x20000
    v_lshrrev_b32 v24, 2, v1
    v_lshlrev_b32 v24, 20, v24
    v_and_b32 v25, 3, v1
    v_lshlrev_b32 v25, 14, v25
    v_add_u32 v24, v24, v25
    s_lshl_b32 s75, s73, 11
    s_add_u32 s75, s75, s42
    s_and_b32 s76, s16, 1
    s_lshl_b32 s76, s76, 10
    s_add_u32 s75, s75, s76
    v_add_u32 v24, s75, v24
    s_mov_b32 s77, 20
    v_mov_b32 v26, 0x80000000
    v_cmp_gt_u32 vcc, s77, v1
    s_nop 1
    v_cndmask_b32 v24, v26, v24, vcc
    s_and_b32 s76, s16, 1
    s_lshl_b32 s76, s76, 4
    v_add_u32 v25, s76, v1
    v_lshlrev_b32 v25, 2, v25
    v_add_u32 v25, s74, v25
    v_lshlrev_b32 v25, 11, v25
    v_add_u32 v25, s45, v25
    v_add_u32 v27, 262144, v25
    v_cmp_gt_u32 vcc, 16, v1
    s_nop 1
    v_cndmask_b32 v25, v26, v25, vcc
    v_cndmask_b32 v27, v26, v27, vcc
    s_cmp_lt_u32 s16, 2
    s_cselect_b64 vcc, -1, 0
    s_nop 1
    v_cndmask_b32 v14, v25, v24, vcc
    v_cndmask_b32 v15, v27, v24, vcc
    s_mov_b32 s77, 128
    s_mov_b32 s78, 896
    s_mov_b32 s79, 256
    s_cmp_lt_u32 s16, 2
    s_cselect_b32 s64, s64, s4
    s_cselect_b32 s65, s65, s5
    s_cselect_b32 s66, s66, s6
    s_cselect_b32 s68, 262144, s79
    s_cselect_b32 s69, 0x10000, s77
    s_cselect_b32 s70, 0x10000, 0
    s_cselect_b32 s71, 983040, s78
    v_mov_b32 v26, 0x80000000
    v_cmp_gt_u32 vcc, 40, v1
    s_and_b32 s76, s16, 1
    s_lshl_b32 s76, s76, 5
    v_cndmask_b32 v63, v26, v63, vcc
    v_add_u32 v25, s76, v1
    v_lshlrev_b32 v25, 2, v25
    v_add_u32 v25, s74, v25
    v_lshlrev_b32 v25, 11, v25
    s_add_u32 s76, s45, 128
    v_add_u32 v25, s76, v25
    v_cmp_gt_u32 vcc, 32, v1
    s_nop 1
    v_cndmask_b32 v25, v26, v25, vcc
    s_cmp_lt_u32 s16, 2
    s_cselect_b64 vcc, -1, 0
    s_nop 1
    v_cndmask_b32 v63, v25, v63, vcc
    v_lshrrev_b32 v24, 4, v1
    v_and_b32 v25, 15, v1
    v_mov_b32 v28, v25
    v_lshrrev_b32 v26, 1, v28
    v_xor_b32 v26, v26, v24
    v_lshlrev_b32 v26, 4, v26
    v_and_b32 v27, 7, v28
    v_lshlrev_b32 v27, 7, v27
    v_add_u32 v26, v26, v27
    v_lshrrev_b32 v27, 3, v28
    v_lshlrev_b32 v27, 14, v27
    v_add_u32 v8, v26, v27
    v_xor_b32 v9, 64, v8
    v_subrev_u32 v28, 1, v25
    v_and_b32 v28, 15, v28
    v_lshrrev_b32 v26, 1, v28
    v_xor_b32 v26, v26, v24
    v_lshlrev_b32 v26, 4, v26
    v_and_b32 v27, 7, v28
    v_lshlrev_b32 v27, 7, v27
    v_add_u32 v26, v26, v27
    v_lshrrev_b32 v27, 3, v28
    v_lshlrev_b32 v27, 14, v27
    v_add_u32 v2, v26, v27
    v_xor_b32 v3, 64, v2
    s_lshl_b32 s46, s16, 12
    v_add_u32 v4, s46, v8
    v_add_u32 v5, s46, v9
    v_lshlrev_b32 v7, 4, v1
    v_add_u32 v7, 65536, v7
    s_lshl_b32 s46, s16, 11
    v_add_u32 v11, s46, v7
    v_lshrrev_b32 v26, 2, v25
    v_and_b32 v27, 1, v24
    v_lshlrev_b32 v27, 2, v27
    v_or_b32 v27, v27, v26
    v_xor_b32 v27, s16, v27
    v_lshlrev_b32 v27, 5, v27
    v_lshlrev_b32 v26, 8, v26
    v_add_u32 v27, v27, v26
    v_mul_u32_u24 v26, 10240, v24
    v_add_u32 v27, v27, v26
    v_and_b32 v26, 3, v25
    v_lshlrev_b32 v26, 3, v26
    v_add_u32 v27, v27, v26
    v_add_u32 v12, 81920, v27
    v_xor_b32 v13, 128, v12
    v_lshlrev_b32 v26, 15, v25
    v_and_b32 v27, 1, v24
    v_lshlrev_b32 v27, 11, v27
    v_add_u32 v26, v26, v27
    v_lshrrev_b32 v27, 1, v24
    v_lshlrev_b32 v27, 4, v27
    v_add_u32 v26, v26, v27
    s_lshl_b32 s46, s16, 5
    s_add_u32 s46, s46, s42
    s_add_u32 s46, s46, s45
    v_add_u32 v26, s46, v26
    v_add_u32 v17, 8192, v26
    v_mov_b32 v27, 0x80000000
    v_cmp_eq_u32 vcc, 0, v25
    s_nop 1
    v_cndmask_b32 v16, v26, v27, vcc
    v_cmp_eq_u32 vcc, 15, v25
    s_nop 1
    v_cndmask_b32 v18, v17, v27, vcc
    s_mov_b32 s32, 0x4038aa3b
    s_mov_b32 s33, 0xbfb8aa3b
    s_mov_b32 s34, 0x41f00000
    s_mov_b32 s35, 0xffff0000
    s_add_u32 m0, s31, 0
    s_nop 0
    buffer_load_dwordx4 v6, s[8:11], s20 offen lds
    buffer_load_dwordx4 v6, s[8:11], s21 offen offset:1024 lds
    buffer_load_dwordx4 v6, s[8:11], s22 offen offset:2048 lds
    buffer_load_dwordx4 v6, s[8:11], s23 offen offset:3072 lds
    s_add_u32 m0, s31, 4096
    s_nop 0
    buffer_load_dwordx4 v6, s[8:11], s24 offen lds
    buffer_load_dwordx4 v6, s[8:11], s25 offen offset:1024 lds
    buffer_load_dwordx4 v6, s[8:11], s26 offen offset:2048 lds
    buffer_load_dwordx4 v6, s[8:11], s27 offen offset:3072 lds
    s_add_u32 m0, s31, 8192
    s_nop 0
    buffer_load_dwordx4 v6, s[8:11], s28 offen lds
    buffer_load_dwordx4 v6, s[8:11], s29 offen offset:1024 lds
    s_add_u32 s8, s8, 0x10000
    s_addc_u32 s9, s9, 0
    s_sub_u32 s10, s10, 0x10000
    s_waitcnt vmcnt(10)
    s_barrier
    ds_read_b128 v[24:27], v4 offset:0
    ds_read_b128 v[28:31], v4 offset:1024
    ds_read_b128 v[32:35], v4 offset:2048
    ds_read_b128 v[36:39], v4 offset:3072
    ds_read_b128 a[64:67], v2 offset:12288
    ds_read_b128 a[68:71], v2 offset:14336
    ds_read_b128 a[72:75], v8 offset:0
    ds_read_b128 a[76:79], v8 offset:2048
    ds_read_b128 a[80:83], v8 offset:4096
    ds_read_b128 a[84:87], v8 offset:6144
    ds_read_b128 a[88:91], v8 offset:8192
    ds_read_b128 a[92:95], v8 offset:10240
    ds_read_b128 a[96:99], v8 offset:12288
    ds_read_b128 a[100:103], v8 offset:14336
    s_waitcnt lgkmcnt(13)
    v_lshlrev_b32 v48, 16, v24
    s_waitcnt lgkmcnt(12)
    v_lshlrev_b32 v49, 16, v28
    v_and_b32 v50, s35, v24
    v_and_b32 v51, s35, v28
    v_add_f32 v48, v48, v49
    v_add_f32 v50, v50, v51
    ds_read_b128 a[104:107], v2 offset:15360
    v_cvt_pk_bf16_f32 v40, v48, v50
    v_lshlrev_b32 v48, 16, v25
    v_lshlrev_b32 v49, 16, v29
    v_and_b32 v50, s35, v25
    v_and_b32 v51, s35, v29
    v_add_f32 v48, v48, v49
    ds_read_b128 a[108:111], v8 offset:1024
    v_add_f32 v50, v50, v51
    v_cvt_pk_bf16_f32 v41, v48, v50
    v_lshlrev_b32 v48, 16, v26
    v_lshlrev_b32 v49, 16, v30
    v_and_b32 v50, s35, v26
    v_and_b32 v51, s35, v30
    ds_read_b128 a[112:115], v8 offset:3072
    v_add_f32 v48, v48, v49
    v_add_f32 v50, v50, v51
    v_cvt_pk_bf16_f32 v42, v48, v50
    v_lshlrev_b32 v48, 16, v27
    v_lshlrev_b32 v49, 16, v31
    v_and_b32 v50, s35, v27
    ds_read_b128 a[116:119], v8 offset:5120
    v_and_b32 v51, s35, v31
    v_add_f32 v48, v48, v49
    v_add_f32 v50, v50, v51
    v_cvt_pk_bf16_f32 v43, v48, v50
    s_waitcnt lgkmcnt(15)
    v_lshlrev_b32 v48, 16, v32
    s_waitcnt lgkmcnt(14)
    v_lshlrev_b32 v49, 16, v36
    ds_read_b128 a[120:123], v8 offset:7168
    v_and_b32 v50, s35, v32
    v_and_b32 v51, s35, v36
    v_add_f32 v48, v48, v49
    v_add_f32 v50, v50, v51
    v_cvt_pk_bf16_f32 v44, v48, v50
    v_lshlrev_b32 v48, 16, v33
    ds_read_b128 a[124:127], v8 offset:9216
    v_lshlrev_b32 v49, 16, v37
    v_and_b32 v50, s35, v33
    v_and_b32 v51, s35, v37
    v_add_f32 v48, v48, v49
    v_add_f32 v50, v50, v51
    v_cvt_pk_bf16_f32 v45, v48, v50
    ds_read_b128 a[128:131], v8 offset:11264
    v_lshlrev_b32 v48, 16, v34
    v_lshlrev_b32 v49, 16, v38
    v_and_b32 v50, s35, v34
    v_and_b32 v51, s35, v38
    v_add_f32 v48, v48, v49
    v_add_f32 v50, v50, v51
    ds_read_b128 a[132:135], v8 offset:13312
    v_cvt_pk_bf16_f32 v46, v48, v50
    v_lshlrev_b32 v48, 16, v35
    v_lshlrev_b32 v49, 16, v39
    v_and_b32 v50, s35, v35
    v_and_b32 v51, s35, v39
    v_add_f32 v48, v48, v49
    ds_read_b128 a[136:139], v8 offset:15360
    v_add_f32 v50, v50, v51
    v_cvt_pk_bf16_f32 v47, v48, v50
    ds_write_b128 v11, v[40:43] offset:0
    ds_write_b128 v11, v[44:47] offset:1024
    s_add_u32 m0, s31, 40960
    s_nop 0
    buffer_load_dwordx4 v6, s[8:11], s20 offen lds
    buffer_load_dwordx4 v6, s[8:11], s21 offen offset:1024 lds
    buffer_load_dwordx4 v6, s[8:11], s22 offen offset:2048 lds
    buffer_load_dwordx4 v6, s[8:11], s23 offen offset:3072 lds
    s_add_u32 m0, s31, 45056
    s_nop 0
    buffer_load_dwordx4 v6, s[8:11], s24 offen lds
    buffer_load_dwordx4 v6, s[8:11], s25 offen offset:1024 lds
    buffer_load_dwordx4 v6, s[8:11], s26 offen offset:2048 lds
    buffer_load_dwordx4 v6, s[8:11], s27 offen offset:3072 lds
    buffer_load_dword v23, v63, s[64:67], 0 offen
    s_waitcnt vmcnt(9) lgkmcnt(0)
    s_barrier
    ds_read_b64_tr_b16 a[180:181], v12 offset:0
    ds_read_b64_tr_b16 a[182:183], v12 offset:1024
    ds_read_b64_tr_b16 v[88:89], v12 offset:4096
    ds_read_b64_tr_b16 v[90:91], v12 offset:5120
    ds_read_b64_tr_b16 v[104:105], v12 offset:8192
    ds_read_b64_tr_b16 v[106:107], v12 offset:9216
    ds_read_b64_tr_b16 v[80:81], v12 offset:2048
    ds_read_b64_tr_b16 v[82:83], v12 offset:3072
    ds_read_b64_tr_b16 a[184:185], v13 offset:0
    ds_read_b64_tr_b16 a[186:187], v13 offset:1024
    ds_read_b64_tr_b16 v[92:93], v13 offset:4096
    ds_read_b64_tr_b16 v[94:95], v13 offset:5120
    ds_read_b64_tr_b16 v[108:109], v13 offset:8192
    ds_read_b64_tr_b16 v[110:111], v13 offset:9216
    ds_read_b64_tr_b16 v[96:97], v12 offset:6144
    ds_read_b64_tr_b16 v[98:99], v12 offset:7168
    ds_read_b64_tr_b16 v[84:85], v13 offset:2048
    ds_read_b64_tr_b16 v[86:87], v13 offset:3072
    ds_read_b64_tr_b16 v[100:101], v13 offset:6144
    ds_read_b64_tr_b16 v[102:103], v13 offset:7168
    s_waitcnt lgkmcnt(0)
    s_barrier
    s_mov_b32 s19, 0
    v_mfma_f32_16x16x32_bf16 v[128:131], a[180:183], a[64:67], 0
    ds_read_b128 a[140:143], v7 offset:6128
    v_lshlrev_b32 v52, 16, v80
    v_mfma_f32_16x16x32_bf16 v[128:131], v[88:91], a[68:71], v[128:131]
    ds_read_b128 a[144:147], v7 offset:7152
    v_lshlrev_b32 v53, 16, v88
    v_mfma_f32_16x16x32_bf16 v[128:131], v[104:107], a[72:75], v[128:131]
    ds_read_b128 a[148:151], v7 offset:0
    v_and_b32 v54, s35, v80
    v_mfma_f32_16x16x32_bf16 v[136:139], v[104:107], a[76:79], 0
    ds_read_b128 a[152:155], v7 offset:1024
    v_and_b32 v55, s35, v88
    v_mfma_f32_16x16x32_bf16 v[136:139], v[88:91], a[72:75], v[136:139]
    ds_read_b128 a[156:159], v7 offset:2048
    v_add_f32 v52, v52, v53
    v_mfma_f32_16x16x32_bf16 v[136:139], a[180:183], a[68:71], v[136:139]
    ds_read_b128 a[160:163], v7 offset:3072
    v_add_f32 v54, v54, v55
    v_mfma_f32_16x16x32_bf16 v[144:147], a[180:183], a[72:75], 0
    ds_read_b128 a[164:167], v7 offset:4096
    v_cvt_pk_bf16_f32 v112, v52, v54
    v_mfma_f32_16x16x32_bf16 v[144:147], v[88:91], a[76:79], v[144:147]
    ds_read_b128 a[168:171], v7 offset:5120
    v_lshlrev_b32 v52, 16, v81
    v_mfma_f32_16x16x32_bf16 v[144:147], v[104:107], a[80:83], v[144:147]
    ds_read_b128 a[172:175], v7 offset:6144
    v_lshlrev_b32 v53, 16, v89
    v_mfma_f32_16x16x32_bf16 v[152:155], v[104:107], a[84:87], 0
    ds_read_b128 a[176:179], v7 offset:7168
    v_and_b32 v54, s35, v81
    v_mfma_f32_16x16x32_bf16 v[152:155], v[88:91], a[80:83], v[152:155]
    v_and_b32 v55, s35, v89
    v_add_f32 v52, v52, v53
    v_mfma_f32_16x16x32_bf16 v[152:155], a[180:183], a[76:79], v[152:155]
    v_add_f32 v54, v54, v55
    v_cvt_pk_bf16_f32 v113, v52, v54
    v_mfma_f32_16x16x32_bf16 v[160:163], a[180:183], a[80:83], 0
    v_lshlrev_b32 v52, 16, v82
    v_lshlrev_b32 v53, 16, v90
    v_mfma_f32_16x16x32_bf16 v[160:163], v[88:91], a[84:87], v[160:163]
    v_and_b32 v54, s35, v82
    v_and_b32 v55, s35, v90
    v_mfma_f32_16x16x32_bf16 v[160:163], v[104:107], a[88:91], v[160:163]
    v_add_f32 v52, v52, v53
    v_add_f32 v54, v54, v55
    v_mfma_f32_16x16x32_bf16 v[168:171], v[104:107], a[92:95], 0
    v_cvt_pk_bf16_f32 v114, v52, v54
    v_lshlrev_b32 v52, 16, v83
    v_mfma_f32_16x16x32_bf16 v[168:171], v[88:91], a[88:91], v[168:171]
    v_lshlrev_b32 v53, 16, v91
    v_and_b32 v54, s35, v83
    v_mfma_f32_16x16x32_bf16 v[168:171], a[180:183], a[84:87], v[168:171]
    v_and_b32 v55, s35, v91
    v_add_f32 v52, v52, v53
    v_mfma_f32_16x16x32_bf16 v[176:179], a[180:183], a[88:91], 0
    v_add_f32 v54, v54, v55
    v_cvt_pk_bf16_f32 v115, v52, v54
    v_mfma_f32_16x16x32_bf16 v[176:179], v[88:91], a[92:95], v[176:179]
    v_lshlrev_b32 v52, 16, v96
    v_lshlrev_b32 v53, 16, v104
    v_mfma_f32_16x16x32_bf16 v[176:179], v[104:107], a[96:99], v[176:179]
    v_and_b32 v54, s35, v96
    v_and_b32 v55, s35, v104
    v_mfma_f32_16x16x32_bf16 v[184:187], v[104:107], a[100:103], 0
    v_add_f32 v52, v52, v53
    v_add_f32 v54, v54, v55
    v_mfma_f32_16x16x32_bf16 v[184:187], v[88:91], a[96:99], v[184:187]
    v_cvt_pk_bf16_f32 v120, v52, v54
    v_lshlrev_b32 v52, 16, v97
    v_mfma_f32_16x16x32_bf16 v[184:187], a[180:183], a[92:95], v[184:187]
    v_lshlrev_b32 v53, 16, v105
    v_and_b32 v54, s35, v97
    v_mfma_f32_16x16x32_bf16 v[132:135], a[184:187], a[64:67], 0
    v_and_b32 v55, s35, v105
    v_add_f32 v52, v52, v53
    v_mfma_f32_16x16x32_bf16 v[132:135], v[92:95], a[68:71], v[132:135]
    v_add_f32 v54, v54, v55
    v_cvt_pk_bf16_f32 v121, v52, v54
    v_mfma_f32_16x16x32_bf16 v[132:135], v[108:111], a[72:75], v[132:135]
    v_lshlrev_b32 v52, 16, v98
    v_lshlrev_b32 v53, 16, v106
    v_mfma_f32_16x16x32_bf16 v[140:143], v[108:111], a[76:79], 0
    v_and_b32 v54, s35, v98
    v_and_b32 v55, s35, v106
    v_mfma_f32_16x16x32_bf16 v[140:143], v[92:95], a[72:75], v[140:143]
    v_add_f32 v52, v52, v53
    v_add_f32 v54, v54, v55
    v_mfma_f32_16x16x32_bf16 v[140:143], a[184:187], a[68:71], v[140:143]
    v_cvt_pk_bf16_f32 v122, v52, v54
    v_lshlrev_b32 v52, 16, v99
    v_mfma_f32_16x16x32_bf16 v[148:151], a[184:187], a[72:75], 0
    v_lshlrev_b32 v53, 16, v107
    v_and_b32 v54, s35, v99
    v_mfma_f32_16x16x32_bf16 v[148:151], v[92:95], a[76:79], v[148:151]
    v_and_b32 v55, s35, v107
    v_add_f32 v52, v52, v53
    v_mfma_f32_16x16x32_bf16 v[148:151], v[108:111], a[80:83], v[148:151]
    v_add_f32 v54, v54, v55
    v_cvt_pk_bf16_f32 v123, v52, v54
    v_mfma_f32_16x16x32_bf16 v[156:159], v[108:111], a[84:87], 0
    v_lshlrev_b32 v52, 16, v84
    v_lshlrev_b32 v53, 16, v92
    v_mfma_f32_16x16x32_bf16 v[156:159], v[92:95], a[80:83], v[156:159]
    v_and_b32 v54, s35, v84
    v_and_b32 v55, s35, v92
    v_mfma_f32_16x16x32_bf16 v[156:159], a[184:187], a[76:79], v[156:159]
    v_add_f32 v52, v52, v53
    v_add_f32 v54, v54, v55
    v_mfma_f32_16x16x32_bf16 v[164:167], a[184:187], a[80:83], 0
    v_cvt_pk_bf16_f32 v116, v52, v54
    v_lshlrev_b32 v52, 16, v85
    v_mfma_f32_16x16x32_bf16 v[164:167], v[92:95], a[84:87], v[164:167]
    v_lshlrev_b32 v53, 16, v93
    v_and_b32 v54, s35, v85
    v_mfma_f32_16x16x32_bf16 v[164:167], v[108:111], a[88:91], v[164:167]
    v_and_b32 v55, s35, v93
    v_add_f32 v52, v52, v53
    v_mfma_f32_16x16x32_bf16 v[172:175], v[108:111], a[92:95], 0
    s_add_u32 m0, s31, 49152
    v_add_f32 v54, v54, v55
    v_cvt_pk_bf16_f32 v117, v52, v54
    v_mfma_f32_16x16x32_bf16 v[172:175], v[92:95], a[88:91], v[172:175]
    buffer_load_dwordx4 v6, s[8:11], s28 offen lds
    v_mfma_f32_16x16x32_bf16 v[172:175], a[184:187], a[84:87], v[172:175]
    ds_read_b128 v[24:27], v5 offset:0
    v_lshlrev_b32 v52, 16, v86
    v_mfma_f32_16x16x32_bf16 v[180:183], a[184:187], a[88:91], 0
    ds_read_b128 v[28:31], v5 offset:1024
    v_lshlrev_b32 v53, 16, v94
    v_mfma_f32_16x16x32_bf16 v[180:183], v[92:95], a[92:95], v[180:183]
    ds_read_b128 v[32:35], v5 offset:2048
    v_and_b32 v54, s35, v86
    v_mfma_f32_16x16x32_bf16 v[180:183], v[108:111], a[96:99], v[180:183]
    ds_read_b128 v[36:39], v5 offset:3072
    v_and_b32 v55, s35, v94
    v_mfma_f32_16x16x32_bf16 v[188:191], v[108:111], a[100:103], 0
    v_add_f32 v52, v52, v53
    v_add_f32 v54, v54, v55
    v_mfma_f32_16x16x32_bf16 v[188:191], v[92:95], a[96:99], v[188:191]
    buffer_load_dwordx4 v6, s[8:11], s29 offen offset:1024 lds
    v_mfma_f32_16x16x32_bf16 v[188:191], a[184:187], a[92:95], v[188:191]
    s_add_u32 s8, s8, 0x10000
    s_addc_u32 s9, s9, 0
    s_sub_u32 s10, s10, 0x10000
    v_mfma_f32_16x16x32_bf16 v[192:195], v[80:83], a[104:107], 0
    ds_read_b128 a[64:67], v3 offset:12288
    v_cvt_pk_bf16_f32 v118, v52, v54
    v_mfma_f32_16x16x32_bf16 v[192:195], v[96:99], a[108:111], v[192:195]
    ds_read_b128 a[68:71], v3 offset:14336
    v_lshlrev_b32 v52, 16, v87
    v_mfma_f32_16x16x32_bf16 v[200:203], v[96:99], a[112:115], 0
    ds_read_b128 a[72:75], v9 offset:0
    v_lshlrev_b32 v53, 16, v95
    v_mfma_f32_16x16x32_bf16 v[200:203], v[80:83], a[108:111], v[200:203]
    ds_read_b128 a[76:79], v9 offset:2048
    v_and_b32 v54, s35, v87
    v_mfma_f32_16x16x32_bf16 v[208:211], v[80:83], a[112:115], 0
    ds_read_b128 a[80:83], v9 offset:4096
    v_and_b32 v55, s35, v95
    v_mfma_f32_16x16x32_bf16 v[208:211], v[96:99], a[116:119], v[208:211]
    ds_read_b128 a[84:87], v9 offset:6144
    v_add_f32 v52, v52, v53
    v_mfma_f32_16x16x32_bf16 v[216:219], v[96:99], a[120:123], 0
    ds_read_b128 a[88:91], v9 offset:8192
    v_add_f32 v54, v54, v55
    v_mfma_f32_16x16x32_bf16 v[216:219], v[80:83], a[116:119], v[216:219]
    ds_read_b128 a[92:95], v9 offset:10240
    v_cvt_pk_bf16_f32 v119, v52, v54
    v_mfma_f32_16x16x32_bf16 v[224:227], v[80:83], a[120:123], 0
    ds_read_b128 a[96:99], v9 offset:12288
    v_lshlrev_b32 v52, 16, v100
    v_mfma_f32_16x16x32_bf16 v[224:227], v[96:99], a[124:127], v[224:227]
    ds_read_b128 a[100:103], v9 offset:14336
    v_lshlrev_b32 v53, 16, v108
    v_mfma_f32_16x16x32_bf16 v[232:235], v[96:99], a[128:131], 0
    v_and_b32 v54, s35, v100
    v_and_b32 v55, s35, v108
    v_mfma_f32_16x16x32_bf16 v[232:235], v[80:83], a[124:127], v[232:235]
    v_add_f32 v52, v52, v53
    v_add_f32 v54, v54, v55
    v_mfma_f32_16x16x32_bf16 v[240:243], v[80:83], a[128:131], 0
    v_cvt_pk_bf16_f32 v124, v52, v54
    v_lshlrev_b32 v52, 16, v101
    v_mfma_f32_16x16x32_bf16 v[240:243], v[96:99], a[132:135], v[240:243]
    v_lshlrev_b32 v53, 16, v109
    v_and_b32 v54, s35, v101
    v_mfma_f32_16x16x32_bf16 v[248:251], v[96:99], a[136:139], 0
    v_and_b32 v55, s35, v109
    v_add_f32 v52, v52, v53
    v_mfma_f32_16x16x32_bf16 v[248:251], v[80:83], a[132:135], v[248:251]
    v_add_f32 v54, v54, v55
    v_cvt_pk_bf16_f32 v125, v52, v54
    v_mfma_f32_16x16x32_bf16 v[196:199], v[84:87], a[104:107], 0
    v_lshlrev_b32 v52, 16, v102
    v_lshlrev_b32 v53, 16, v110
    v_mfma_f32_16x16x32_bf16 v[196:199], v[100:103], a[108:111], v[196:199]
    s_add_u32 m0, s30, 32768
    v_and_b32 v54, s35, v102
    v_and_b32 v55, s35, v110
    v_mfma_f32_16x16x32_bf16 v[204:207], v[100:103], a[112:115], 0
    buffer_load_dwordx4 v64, s[4:7], s17 offen lds
    v_mfma_f32_16x16x32_bf16 v[204:207], v[84:87], a[108:111], v[204:207]
    ds_read_b128 a[104:107], v3 offset:15360
    v_add_f32 v52, v52, v53
    v_mfma_f32_16x16x32_bf16 v[212:215], v[84:87], a[112:115], 0
    ds_read_b128 a[108:111], v9 offset:1024
    v_add_f32 v54, v54, v55
    v_mfma_f32_16x16x32_bf16 v[212:215], v[100:103], a[116:119], v[212:215]
    buffer_load_dwordx4 v65, s[4:7], s17 offen offset:1024 lds
    v_mfma_f32_16x16x32_bf16 v[220:223], v[100:103], a[120:123], 0
    ds_read_b128 a[112:115], v9 offset:3072
    v_cvt_pk_bf16_f32 v126, v52, v54
    v_mfma_f32_16x16x32_bf16 v[220:223], v[84:87], a[116:119], v[220:223]
    v_lshlrev_b32 v52, 16, v103
    v_lshlrev_b32 v53, 16, v111
    v_mfma_f32_16x16x32_bf16 v[228:231], v[84:87], a[120:123], 0
    buffer_load_dwordx4 v66, s[4:7], s17 offen offset:2048 lds
    v_mfma_f32_16x16x32_bf16 v[228:231], v[100:103], a[124:127], v[228:231]
    ds_read_b128 a[116:119], v9 offset:5120
    v_and_b32 v54, s35, v103
    v_mfma_f32_16x16x32_bf16 v[236:239], v[100:103], a[128:131], 0
    ds_read_b128 a[120:123], v9 offset:7168
    v_and_b32 v55, s35, v111
    v_mfma_f32_16x16x32_bf16 v[236:239], v[84:87], a[124:127], v[236:239]
    buffer_load_dwordx4 v67, s[4:7], s17 offen offset:3072 lds
    v_mfma_f32_16x16x32_bf16 v[244:247], v[84:87], a[128:131], 0
    ds_read_b128 a[124:127], v9 offset:9216
    v_add_f32 v52, v52, v53
    v_mfma_f32_16x16x32_bf16 v[244:247], v[100:103], a[132:135], v[244:247]
    s_waitcnt lgkmcnt(15)
    s_add_u32 m0, s30, 49152
    v_add_f32 v54, v54, v55
    v_cvt_pk_bf16_f32 v127, v52, v54
    v_lshlrev_b32 v48, 16, v24
    v_lshlrev_b32 v49, 16, v28
    v_and_b32 v50, s35, v24
    v_and_b32 v51, s35, v28
    v_add_f32 v48, v48, v49
    v_add_f32 v50, v50, v51
    v_cvt_pk_bf16_f32 v40, v48, v50
    v_lshlrev_b32 v48, 16, v25
    v_lshlrev_b32 v49, 16, v29
    v_and_b32 v50, s35, v25
    v_and_b32 v51, s35, v29
    v_add_f32 v48, v48, v49
    v_add_f32 v50, v50, v51
    v_cvt_pk_bf16_f32 v41, v48, v50
    v_mfma_f32_16x16x32_bf16 v[252:255], v[100:103], a[136:139], 0
    buffer_load_dwordx4 v68, s[4:7], s17 offen lds
    v_mfma_f32_16x16x32_bf16 v[252:255], v[84:87], a[132:135], v[252:255]
    ds_read_b128 a[128:131], v9 offset:11264
    v_lshlrev_b32 v48, 16, v26
    v_lshlrev_b32 v49, 16, v30
    v_and_b32 v50, s35, v26
    v_and_b32 v51, s35, v30
    v_add_f32 v48, v48, v49
    v_add_f32 v50, v50, v51
    v_cvt_pk_bf16_f32 v42, v48, v50
    v_lshlrev_b32 v48, 16, v27
    v_lshlrev_b32 v49, 16, v31
    v_and_b32 v50, s35, v27
    v_and_b32 v51, s35, v31
    v_add_f32 v48, v48, v49
    v_add_f32 v50, v50, v51
    v_cvt_pk_bf16_f32 v43, v48, v50
    v_lshlrev_b32 v48, 16, v32
    v_lshlrev_b32 v49, 16, v36
    v_and_b32 v50, s35, v32
    v_and_b32 v51, s35, v36
    v_mfma_f32_16x16x32_bf16 a[0:3], a[180:183], a[140:143], 0
    ds_write_b128 v11, v[40:43] offset:8192
    v_add_f32 v48, v48, v49
    v_add_f32 v50, v50, v51
    v_cvt_pk_bf16_f32 v44, v48, v50
    v_lshlrev_b32 v48, 16, v33
    v_mfma_f32_16x16x32_bf16 a[0:3], v[112:115], a[144:147], a[0:3]
    buffer_load_dwordx4 v69, s[4:7], s17 offen offset:1024 lds
    v_mfma_f32_16x16x32_bf16 a[0:3], v[120:123], a[148:151], a[0:3]
    ds_read_b128 a[132:135], v9 offset:13312
    v_lshlrev_b32 v49, 16, v37
    v_and_b32 v50, s35, v33
    v_and_b32 v51, s35, v37
    v_add_f32 v48, v48, v49
    v_add_f32 v50, v50, v51
    v_mfma_f32_16x16x32_bf16 a[8:11], v[120:123], a[152:155], 0
    ds_read_b128 a[136:139], v9 offset:15360
    v_cvt_pk_bf16_f32 v45, v48, v50
    v_lshlrev_b32 v48, 16, v34
    v_lshlrev_b32 v49, 16, v38
    v_and_b32 v50, s35, v34
    v_mfma_f32_16x16x32_bf16 a[8:11], v[112:115], a[148:151], a[8:11]
    buffer_load_dwordx4 v70, s[4:7], s17 offen offset:2048 lds
    v_mfma_f32_16x16x32_bf16 a[8:11], a[180:183], a[144:147], a[8:11]
    v_and_b32 v51, s35, v38
    v_add_f32 v48, v48, v49
    v_add_f32 v50, v50, v51
    v_cvt_pk_bf16_f32 v46, v48, v50
    v_lshlrev_b32 v48, 16, v35
    v_lshlrev_b32 v49, 16, v39
    v_mfma_f32_16x16x32_bf16 a[16:19], a[180:183], a[148:151], 0
    v_and_b32 v50, s35, v35
    v_and_b32 v51, s35, v39
    v_add_f32 v48, v48, v49
    v_add_f32 v50, v50, v51
    v_cvt_pk_bf16_f32 v47, v48, v50
    v_mfma_f32_16x16x32_bf16 a[16:19], v[112:115], a[152:155], a[16:19]
    buffer_load_dwordx4 v71, s[4:7], s17 offen offset:3072 lds
    v_mfma_f32_16x16x32_bf16 a[16:19], v[120:123], a[156:159], a[16:19]
    s_add_u32 s17, s17, 128
    ds_write_b128 v11, v[44:47] offset:9216
    v_mfma_f32_16x16x32_bf16 a[24:27], v[120:123], a[160:163], 0
    s_add_u32 m0, s31, 0
    v_mfma_f32_16x16x32_bf16 a[24:27], v[112:115], a[156:159], a[24:27]
    buffer_load_dwordx4 v6, s[8:11], s20 offen lds
    v_mfma_f32_16x16x32_bf16 a[24:27], a[180:183], a[152:155], a[24:27]
    v_mfma_f32_16x16x32_bf16 a[32:35], a[180:183], a[156:159], 0
    v_mfma_f32_16x16x32_bf16 a[32:35], v[112:115], a[160:163], a[32:35]
    buffer_load_dwordx4 v6, s[8:11], s21 offen offset:1024 lds
    v_mfma_f32_16x16x32_bf16 a[32:35], v[120:123], a[164:167], a[32:35]
    v_mfma_f32_16x16x32_bf16 a[40:43], v[120:123], a[168:171], 0
    s_waitcnt vmcnt(10)
    s_barrier
    v_mfma_f32_16x16x32_bf16 a[40:43], v[112:115], a[164:167], a[40:43]
    buffer_load_dwordx4 v6, s[8:11], s22 offen offset:2048 lds
    v_mfma_f32_16x16x32_bf16 a[40:43], a[180:183], a[160:163], a[40:43]
    ds_read_b64_tr_b16 a[188:189], v12 offset:40960
    v_mfma_f32_16x16x32_bf16 a[48:51], a[180:183], a[164:167], 0
    ds_read_b64_tr_b16 a[190:191], v12 offset:41984
    v_mfma_f32_16x16x32_bf16 a[48:51], v[112:115], a[168:171], a[48:51]
    buffer_load_dwordx4 v6, s[8:11], s23 offen offset:3072 lds
    v_mfma_f32_16x16x32_bf16 a[48:51], v[120:123], a[172:175], a[48:51]
    ds_read_b64_tr_b16 v[88:89], v12 offset:45056
    v_mfma_f32_16x16x32_bf16 a[56:59], v[120:123], a[176:179], 0
    s_add_u32 m0, s31, 4096
    ds_read_b64_tr_b16 v[90:91], v12 offset:46080
    v_mfma_f32_16x16x32_bf16 a[56:59], v[112:115], a[172:175], a[56:59]
    buffer_load_dwordx4 v6, s[8:11], s24 offen lds
    v_mfma_f32_16x16x32_bf16 a[56:59], a[180:183], a[168:171], a[56:59]
    ds_read_b64_tr_b16 v[104:105], v12 offset:49152
    v_mfma_f32_16x16x32_bf16 a[4:7], a[184:187], a[140:143], 0
    ds_read_b64_tr_b16 v[106:107], v12 offset:50176
    v_mfma_f32_16x16x32_bf16 a[4:7], v[116:119], a[144:147], a[4:7]
    buffer_load_dwordx4 v6, s[8:11], s25 offen offset:1024 lds
    v_mfma_f32_16x16x32_bf16 a[4:7], v[124:127], a[148:151], a[4:7]
    ds_read_b64_tr_b16 a[192:193], v13 offset:40960
    v_mfma_f32_16x16x32_bf16 a[12:15], v[124:127], a[152:155], 0
    ds_read_b64_tr_b16 a[194:195], v13 offset:41984
    v_mfma_f32_16x16x32_bf16 a[12:15], v[116:119], a[148:151], a[12:15]
    buffer_load_dwordx4 v6, s[8:11], s26 offen offset:2048 lds
    v_mfma_f32_16x16x32_bf16 a[12:15], a[184:187], a[144:147], a[12:15]
    ds_read_b64_tr_b16 v[92:93], v13 offset:45056
    v_mfma_f32_16x16x32_bf16 a[20:23], a[184:187], a[148:151], 0
    ds_read_b64_tr_b16 v[94:95], v13 offset:46080
    v_mfma_f32_16x16x32_bf16 a[20:23], v[116:119], a[152:155], a[20:23]
    buffer_load_dwordx4 v6, s[8:11], s27 offen offset:3072 lds
    v_mfma_f32_16x16x32_bf16 a[20:23], v[124:127], a[156:159], a[20:23]
    ds_read_b64_tr_b16 v[108:109], v13 offset:49152
    v_mfma_f32_16x16x32_bf16 a[28:31], v[124:127], a[160:163], 0
    s_add_u32 m0, s31, 8192
    ds_read_b64_tr_b16 v[110:111], v13 offset:50176
    v_mfma_f32_16x16x32_bf16 a[28:31], v[116:119], a[156:159], a[28:31]
    buffer_load_dwordx4 v6, s[8:11], s28 offen lds
    v_mfma_f32_16x16x32_bf16 a[28:31], a[184:187], a[152:155], a[28:31]
    ds_read_b64_tr_b16 v[80:81], v12 offset:43008
    v_mfma_f32_16x16x32_bf16 a[36:39], a[184:187], a[156:159], 0
    ds_read_b64_tr_b16 v[82:83], v12 offset:44032
    v_mfma_f32_16x16x32_bf16 a[36:39], v[116:119], a[160:163], a[36:39]
    buffer_load_dwordx4 v6, s[8:11], s29 offen offset:1024 lds
    v_mfma_f32_16x16x32_bf16 a[36:39], v[124:127], a[164:167], a[36:39]
    s_add_u32 s8, s8, 0x10000
    s_addc_u32 s9, s9, 0
    s_sub_u32 s10, s10, 0x10000
    v_mfma_f32_16x16x32_bf16 a[44:47], v[124:127], a[168:171], 0
    buffer_load_dword v23, v14, s[64:67], s68 offen
    v_mfma_f32_16x16x32_bf16 a[44:47], v[116:119], a[164:167], a[44:47]
    s_add_u32 s68, s68, s70
    ds_read_b64_tr_b16 v[96:97], v12 offset:47104
    s_min_u32 s68, s68, s71
    v_mfma_f32_16x16x32_bf16 a[44:47], a[184:187], a[160:163], a[44:47]
    ds_read_b64_tr_b16 v[98:99], v12 offset:48128
    v_mfma_f32_16x16x32_bf16 a[52:55], a[184:187], a[164:167], 0
    ds_read_b64_tr_b16 v[84:85], v13 offset:43008
    v_mfma_f32_16x16x32_bf16 a[52:55], v[116:119], a[168:171], a[52:55]
    ds_read_b64_tr_b16 v[86:87], v13 offset:44032
    v_mfma_f32_16x16x32_bf16 a[52:55], v[124:127], a[172:175], a[52:55]
    ds_read_b64_tr_b16 v[100:101], v13 offset:47104
    v_mfma_f32_16x16x32_bf16 a[60:63], v[124:127], a[176:179], 0
    ds_read_b64_tr_b16 v[102:103], v13 offset:48128
    v_mfma_f32_16x16x32_bf16 a[60:63], v[116:119], a[172:175], a[60:63]
    v_mfma_f32_16x16x32_bf16 a[60:63], a[184:187], a[168:171], a[60:63]
    s_waitcnt lgkmcnt(7)
    s_waitcnt lgkmcnt(0)
    v_lshlrev_b32 v52, 16, v80
    v_lshlrev_b32 v53, 16, v88
    v_and_b32 v54, s35, v80
    v_and_b32 v55, s35, v88
    v_add_f32 v52, v52, v53
    v_add_f32 v54, v54, v55
    v_cvt_pk_bf16_f32 v112, v52, v54
    s_branch L_loop
.p2align 6
L_loop:
    v_mfma_f32_16x16x32_bf16 v[128:131], a[188:191], a[64:67], v[128:131]
    s_barrier
    v_lshlrev_b32 v52, 16, v81
    v_lshlrev_b32 v53, 16, v89
    v_mfma_f32_16x16x32_bf16 v[128:131], v[88:91], a[68:71], v[128:131]
    s_add_u32 m0, s31, 40960
    v_and_b32 v54, s35, v81
    v_and_b32 v55, s35, v89
    v_mfma_f32_16x16x32_bf16 v[128:131], v[104:107], a[72:75], v[128:131]
    buffer_load_dwordx4 v6, s[8:11], s20 offen lds
    v_mfma_f32_16x16x32_bf16 v[136:139], v[104:107], a[76:79], v[136:139]
    v_add_f32 v52, v52, v53
    v_add_f32 v54, v54, v55
    v_mfma_f32_16x16x32_bf16 v[136:139], v[88:91], a[72:75], v[136:139]
    v_cvt_pk_bf16_f32 v113, v52, v54
    v_lshlrev_b32 v52, 16, v82
    v_mfma_f32_16x16x32_bf16 v[136:139], a[188:191], a[68:71], v[136:139]
    v_lshlrev_b32 v53, 16, v90
    v_and_b32 v54, s35, v82
    v_mfma_f32_16x16x32_bf16 v[144:147], a[188:191], a[72:75], v[144:147]
    v_and_b32 v55, s35, v90
    v_add_f32 v52, v52, v53
    v_mfma_f32_16x16x32_bf16 v[144:147], v[88:91], a[76:79], v[144:147]
    v_add_f32 v54, v54, v55
    v_cvt_pk_bf16_f32 v114, v52, v54
    v_mfma_f32_16x16x32_bf16 v[144:147], v[104:107], a[80:83], v[144:147]
    buffer_load_dwordx4 v6, s[8:11], s21 offen offset:1024 lds
    v_mfma_f32_16x16x32_bf16 v[152:155], v[104:107], a[84:87], v[152:155]
    v_lshlrev_b32 v52, 16, v83
    v_lshlrev_b32 v53, 16, v91
    v_mfma_f32_16x16x32_bf16 v[152:155], v[88:91], a[80:83], v[152:155]
    v_and_b32 v54, s35, v83
    v_and_b32 v55, s35, v91
    v_mfma_f32_16x16x32_bf16 v[152:155], a[188:191], a[76:79], v[152:155]
    v_add_f32 v52, v52, v53
    v_add_f32 v54, v54, v55
    v_mfma_f32_16x16x32_bf16 v[160:163], a[188:191], a[80:83], v[160:163]
    v_cvt_pk_bf16_f32 v115, v52, v54
    v_lshlrev_b32 v52, 16, v96
    v_mfma_f32_16x16x32_bf16 v[160:163], v[88:91], a[84:87], v[160:163]
    v_lshlrev_b32 v53, 16, v104
    v_and_b32 v54, s35, v96
    v_mfma_f32_16x16x32_bf16 v[160:163], v[104:107], a[88:91], v[160:163]
    buffer_load_dwordx4 v6, s[8:11], s22 offen offset:2048 lds
    v_mfma_f32_16x16x32_bf16 v[168:171], v[104:107], a[92:95], v[168:171]
    v_and_b32 v55, s35, v104
    v_add_f32 v52, v52, v53
    v_mfma_f32_16x16x32_bf16 v[168:171], v[88:91], a[88:91], v[168:171]
    v_add_f32 v54, v54, v55
    v_cvt_pk_bf16_f32 v120, v52, v54
    v_mfma_f32_16x16x32_bf16 v[168:171], a[188:191], a[84:87], v[168:171]
    v_lshlrev_b32 v52, 16, v97
    v_lshlrev_b32 v53, 16, v105
    v_mfma_f32_16x16x32_bf16 v[176:179], a[188:191], a[88:91], v[176:179]
    v_and_b32 v54, s35, v97
    v_and_b32 v55, s35, v105
    v_mfma_f32_16x16x32_bf16 v[176:179], v[88:91], a[92:95], v[176:179]
    v_add_f32 v52, v52, v53
    v_add_f32 v54, v54, v55
    v_mfma_f32_16x16x32_bf16 v[176:179], v[104:107], a[96:99], v[176:179]
    buffer_load_dwordx4 v6, s[8:11], s23 offen offset:3072 lds
    v_mfma_f32_16x16x32_bf16 v[184:187], v[104:107], a[100:103], v[184:187]
    v_cvt_pk_bf16_f32 v121, v52, v54
    v_lshlrev_b32 v52, 16, v98
    v_mfma_f32_16x16x32_bf16 v[184:187], v[88:91], a[96:99], v[184:187]
    v_lshlrev_b32 v53, 16, v106
    v_and_b32 v54, s35, v98
    v_mfma_f32_16x16x32_bf16 v[184:187], a[188:191], a[92:95], v[184:187]
    v_and_b32 v55, s35, v106
    v_add_f32 v52, v52, v53
    v_mfma_f32_16x16x32_bf16 v[132:135], a[192:195], a[64:67], v[132:135]
    v_add_f32 v54, v54, v55
    v_cvt_pk_bf16_f32 v122, v52, v54
    v_mfma_f32_16x16x32_bf16 v[132:135], v[92:95], a[68:71], v[132:135]
    s_add_u32 m0, s31, 45056
    v_lshlrev_b32 v52, 16, v99
    v_lshlrev_b32 v53, 16, v107
    v_mfma_f32_16x16x32_bf16 v[132:135], v[108:111], a[72:75], v[132:135]
    buffer_load_dwordx4 v6, s[8:11], s24 offen lds
    v_mfma_f32_16x16x32_bf16 v[140:143], v[108:111], a[76:79], v[140:143]
    v_and_b32 v54, s35, v99
    v_and_b32 v55, s35, v107
    v_mfma_f32_16x16x32_bf16 v[140:143], v[92:95], a[72:75], v[140:143]
    v_add_f32 v52, v52, v53
    v_add_f32 v54, v54, v55
    v_mfma_f32_16x16x32_bf16 v[140:143], a[192:195], a[68:71], v[140:143]
    v_cvt_pk_bf16_f32 v123, v52, v54
    v_lshlrev_b32 v52, 16, v84
    v_mfma_f32_16x16x32_bf16 v[148:151], a[192:195], a[72:75], v[148:151]
    v_lshlrev_b32 v53, 16, v92
    v_and_b32 v54, s35, v84
    v_mfma_f32_16x16x32_bf16 v[148:151], v[92:95], a[76:79], v[148:151]
    v_and_b32 v55, s35, v92
    v_add_f32 v52, v52, v53
    v_mfma_f32_16x16x32_bf16 v[148:151], v[108:111], a[80:83], v[148:151]
    buffer_load_dwordx4 v6, s[8:11], s25 offen offset:1024 lds
    v_mfma_f32_16x16x32_bf16 v[156:159], v[108:111], a[84:87], v[156:159]
    v_add_f32 v54, v54, v55
    v_cvt_pk_bf16_f32 v116, v52, v54
    v_mfma_f32_16x16x32_bf16 v[156:159], v[92:95], a[80:83], v[156:159]
    v_lshlrev_b32 v52, 16, v85
    v_lshlrev_b32 v53, 16, v93
    v_mfma_f32_16x16x32_bf16 v[156:159], a[192:195], a[76:79], v[156:159]
    v_and_b32 v54, s35, v85
    v_and_b32 v55, s35, v93
    v_mfma_f32_16x16x32_bf16 v[164:167], a[192:195], a[80:83], v[164:167]
    v_add_f32 v52, v52, v53
    v_add_f32 v54, v54, v55
    v_mfma_f32_16x16x32_bf16 v[164:167], v[92:95], a[84:87], v[164:167]
    v_cvt_pk_bf16_f32 v117, v52, v54
    v_lshlrev_b32 v52, 16, v86
    v_mfma_f32_16x16x32_bf16 v[164:167], v[108:111], a[88:91], v[164:167]
    buffer_load_dwordx4 v6, s[8:11], s26 offen offset:2048 lds
    v_mfma_f32_16x16x32_bf16 v[172:175], v[108:111], a[92:95], v[172:175]
    v_lshlrev_b32 v53, 16, v94
    v_and_b32 v54, s35, v86
    v_mfma_f32_16x16x32_bf16 v[172:175], v[92:95], a[88:91], v[172:175]
    v_and_b32 v55, s35, v94
    v_add_f32 v52, v52, v53
    v_mfma_f32_16x16x32_bf16 v[172:175], a[192:195], a[84:87], v[172:175]
    v_add_f32 v54, v54, v55
    v_cvt_pk_bf16_f32 v118, v52, v54
    v_mfma_f32_16x16x32_bf16 v[180:183], a[192:195], a[88:91], v[180:183]
    v_lshlrev_b32 v52, 16, v87
    v_lshlrev_b32 v53, 16, v95
    v_mfma_f32_16x16x32_bf16 v[180:183], v[92:95], a[92:95], v[180:183]
    v_and_b32 v54, s35, v87
    v_and_b32 v55, s35, v95
    v_mfma_f32_16x16x32_bf16 v[180:183], v[108:111], a[96:99], v[180:183]
    buffer_load_dwordx4 v6, s[8:11], s27 offen offset:3072 lds
    v_mfma_f32_16x16x32_bf16 v[188:191], v[108:111], a[100:103], v[188:191]
    v_add_f32 v52, v52, v53
    v_add_f32 v54, v54, v55
    v_mfma_f32_16x16x32_bf16 v[188:191], v[92:95], a[96:99], v[188:191]
    v_cvt_pk_bf16_f32 v119, v52, v54
    v_lshlrev_b32 v52, 16, v100
    v_mfma_f32_16x16x32_bf16 v[188:191], a[192:195], a[92:95], v[188:191]
    v_lshlrev_b32 v53, 16, v108
    v_and_b32 v54, s35, v100
    v_mfma_f32_16x16x32_bf16 v[192:195], v[80:83], a[104:107], v[192:195]
    v_and_b32 v55, s35, v108
    v_add_f32 v52, v52, v53
    v_mfma_f32_16x16x32_bf16 v[192:195], v[96:99], a[108:111], v[192:195]
    s_add_u32 m0, s31, 49152
    v_add_f32 v54, v54, v55
    v_cvt_pk_bf16_f32 v124, v52, v54
    v_mfma_f32_16x16x32_bf16 v[200:203], v[96:99], a[112:115], v[200:203]
    buffer_load_dwordx4 v6, s[8:11], s28 offen lds
    v_mfma_f32_16x16x32_bf16 v[200:203], v[80:83], a[108:111], v[200:203]
    v_lshlrev_b32 v52, 16, v101
    v_lshlrev_b32 v53, 16, v109
    v_mfma_f32_16x16x32_bf16 v[208:211], v[80:83], a[112:115], v[208:211]
    v_and_b32 v54, s35, v101
    v_and_b32 v55, s35, v109
    v_mfma_f32_16x16x32_bf16 v[208:211], v[96:99], a[116:119], v[208:211]
    v_add_f32 v52, v52, v53
    v_add_f32 v54, v54, v55
    v_mfma_f32_16x16x32_bf16 v[216:219], v[96:99], a[120:123], v[216:219]
    v_cvt_pk_bf16_f32 v125, v52, v54
    v_lshlrev_b32 v52, 16, v102
    v_mfma_f32_16x16x32_bf16 v[216:219], v[80:83], a[116:119], v[216:219]
    v_lshlrev_b32 v53, 16, v110
    v_and_b32 v54, s35, v102
    v_mfma_f32_16x16x32_bf16 v[224:227], v[80:83], a[120:123], v[224:227]
    buffer_load_dwordx4 v6, s[8:11], s29 offen offset:1024 lds
    v_mfma_f32_16x16x32_bf16 v[224:227], v[96:99], a[124:127], v[224:227]
    s_add_u32 s8, s8, 0x10000
    s_addc_u32 s9, s9, 0
    v_and_b32 v55, s35, v110
    v_mfma_f32_16x16x32_bf16 v[232:235], v[96:99], a[128:131], v[232:235]
    s_sub_u32 s10, s10, 0x10000
    v_add_f32 v52, v52, v53
    v_add_f32 v54, v54, v55
    v_mfma_f32_16x16x32_bf16 v[232:235], v[80:83], a[124:127], v[232:235]
    s_waitcnt vmcnt(11) lgkmcnt(0)
    s_barrier
    v_cvt_pk_bf16_f32 v126, v52, v54
    v_mfma_f32_16x16x32_bf16 v[240:243], v[80:83], a[128:131], v[240:243]
    s_add_u32 m0, s30, 0
    ds_read_b128 v[24:27], v4 offset:32768
    v_lshlrev_b32 v52, 16, v103
    v_mfma_f32_16x16x32_bf16 v[240:243], v[96:99], a[132:135], v[240:243]
    buffer_load_dwordx4 v64, s[4:7], s17 offen lds
    v_mfma_f32_16x16x32_bf16 v[248:251], v[96:99], a[136:139], v[248:251]
    ds_read_b128 v[28:31], v4 offset:33792
    v_lshlrev_b32 v53, 16, v111
    v_mfma_f32_16x16x32_bf16 v[248:251], v[80:83], a[132:135], v[248:251]
    ds_read_b128 v[32:35], v4 offset:34816
    v_and_b32 v54, s35, v103
    v_mfma_f32_16x16x32_bf16 v[196:199], v[84:87], a[104:107], v[196:199]
    ds_read_b128 v[36:39], v4 offset:35840
    v_and_b32 v55, s35, v111
    v_mfma_f32_16x16x32_bf16 v[196:199], v[100:103], a[108:111], v[196:199]
    ds_read_b128 a[140:143], v7 offset:14320
    v_add_f32 v52, v52, v53
    v_mfma_f32_16x16x32_bf16 v[204:207], v[100:103], a[112:115], v[204:207]
    ds_read_b128 a[144:147], v7 offset:15344
    v_add_f32 v54, v54, v55
    v_mfma_f32_16x16x32_bf16 v[204:207], v[84:87], a[108:111], v[204:207]
    buffer_load_dwordx4 v65, s[4:7], s17 offen offset:1024 lds
    v_mfma_f32_16x16x32_bf16 v[212:215], v[84:87], a[112:115], v[212:215]
    ds_read_b128 a[148:151], v7 offset:8192
    v_cvt_pk_bf16_f32 v127, v52, v54
    v_mfma_f32_16x16x32_bf16 v[212:215], v[100:103], a[116:119], v[212:215]
    ds_read_b128 a[152:155], v7 offset:9216
    v_mfma_f32_16x16x32_bf16 v[220:223], v[100:103], a[120:123], v[220:223]
    s_waitcnt lgkmcnt(7)
    ds_read_b128 a[156:159], v7 offset:10240
    v_lshlrev_b32 v48, 16, v24
    v_mfma_f32_16x16x32_bf16 v[220:223], v[84:87], a[116:119], v[220:223]
    s_waitcnt lgkmcnt(7)
    ds_read_b128 a[160:163], v7 offset:11264
    v_lshlrev_b32 v49, 16, v28
    v_mfma_f32_16x16x32_bf16 v[228:231], v[84:87], a[120:123], v[228:231]
    ds_read_b128 a[164:167], v7 offset:12288
    v_and_b32 v50, s35, v24
    v_mfma_f32_16x16x32_bf16 v[228:231], v[100:103], a[124:127], v[228:231]
    buffer_load_dwordx4 v66, s[4:7], s17 offen offset:2048 lds
    v_mfma_f32_16x16x32_bf16 v[236:239], v[100:103], a[128:131], v[236:239]
    ds_read_b128 a[168:171], v7 offset:13312
    v_and_b32 v51, s35, v28
    v_mfma_f32_16x16x32_bf16 v[236:239], v[84:87], a[124:127], v[236:239]
    ds_read_b128 a[172:175], v7 offset:14336
    v_add_f32 v48, v48, v49
    v_mfma_f32_16x16x32_bf16 v[244:247], v[84:87], a[128:131], v[244:247]
    ds_read_b128 a[176:179], v7 offset:15360
    v_add_f32 v50, v50, v51
    v_mfma_f32_16x16x32_bf16 v[244:247], v[100:103], a[132:135], v[244:247]
    ds_read_b128 a[64:67], v2 offset:45056
    v_cvt_pk_bf16_f32 v40, v48, v50
    v_mfma_f32_16x16x32_bf16 v[252:255], v[100:103], a[136:139], v[252:255]
    ds_read_b128 a[68:71], v2 offset:47104
    v_lshlrev_b32 v48, 16, v25
    v_mfma_f32_16x16x32_bf16 v[252:255], v[84:87], a[132:135], v[252:255]
    s_waitcnt lgkmcnt(11)
    buffer_load_dwordx4 v67, s[4:7], s17 offen offset:3072 lds
    v_mfma_f32_16x16x32_bf16 a[0:3], a[188:191], a[140:143], a[0:3]
    s_waitcnt lgkmcnt(10)
    ds_read_b128 a[72:75], v8 offset:32768
    v_lshlrev_b32 v49, 16, v29
    v_mfma_f32_16x16x32_bf16 a[0:3], v[112:115], a[144:147], a[0:3]
    s_waitcnt lgkmcnt(10)
    ds_read_b128 a[76:79], v8 offset:34816
    v_and_b32 v50, s35, v25
    v_mfma_f32_16x16x32_bf16 a[0:3], v[120:123], a[148:151], a[0:3]
    s_waitcnt lgkmcnt(10)
    buffer_load_dword v23, v15, s[64:67], s68 offen
    v_mfma_f32_16x16x32_bf16 a[8:11], v[120:123], a[152:155], a[8:11]
    s_add_u32 s68, s68, s69
    ds_read_b128 a[80:83], v8 offset:36864
    v_and_b32 v51, s35, v29
    v_mfma_f32_16x16x32_bf16 a[8:11], v[112:115], a[148:151], a[8:11]
    s_min_u32 s68, s68, s71
    ds_read_b128 a[84:87], v8 offset:38912
    v_add_f32 v48, v48, v49
    v_mfma_f32_16x16x32_bf16 a[8:11], a[188:191], a[144:147], a[8:11]
    ds_read_b128 a[88:91], v8 offset:40960
    v_add_f32 v50, v50, v51
    v_mfma_f32_16x16x32_bf16 a[16:19], a[188:191], a[148:151], a[16:19]
    ds_read_b128 a[92:95], v8 offset:43008
    v_cvt_pk_bf16_f32 v41, v48, v50
    v_mfma_f32_16x16x32_bf16 a[16:19], v[112:115], a[152:155], a[16:19]
    s_waitcnt lgkmcnt(13)
    ds_read_b128 a[96:99], v8 offset:45056
    v_lshlrev_b32 v48, 16, v26
    v_mfma_f32_16x16x32_bf16 a[16:19], v[120:123], a[156:159], a[16:19]
    s_waitcnt lgkmcnt(13)
    ds_read_b128 a[100:103], v8 offset:47104
    v_lshlrev_b32 v49, 16, v30
    v_mfma_f32_16x16x32_bf16 a[24:27], v[120:123], a[160:163], a[24:27]
    ds_read_b64_tr_b16 a[180:181], v12 offset:0
    v_and_b32 v50, s35, v26
    v_mfma_f32_16x16x32_bf16 a[24:27], v[112:115], a[156:159], a[24:27]
    ds_read_b64_tr_b16 a[182:183], v12 offset:1024
    v_and_b32 v51, s35, v30
    v_mfma_f32_16x16x32_bf16 a[24:27], a[188:191], a[152:155], a[24:27]
    ds_read_b64_tr_b16 a[184:185], v13 offset:0
    v_add_f32 v48, v48, v49
    v_mfma_f32_16x16x32_bf16 a[32:35], a[188:191], a[156:159], a[32:35]
    ds_read_b64_tr_b16 a[186:187], v13 offset:1024
    v_add_f32 v50, v50, v51
    v_mfma_f32_16x16x32_bf16 a[32:35], v[112:115], a[160:163], a[32:35]
    s_waitcnt lgkmcnt(15)
    ds_read_b64_tr_b16 v[88:89], v12 offset:4096
    v_cvt_pk_bf16_f32 v42, v48, v50
    v_mfma_f32_16x16x32_bf16 a[32:35], v[120:123], a[164:167], a[32:35]
    ds_read_b64_tr_b16 v[90:91], v12 offset:5120
    v_lshlrev_b32 v48, 16, v27
    v_mfma_f32_16x16x32_bf16 a[40:43], v[120:123], a[168:171], a[40:43]
    ds_read_b64_tr_b16 v[104:105], v12 offset:8192
    v_lshlrev_b32 v49, 16, v31
    v_mfma_f32_16x16x32_bf16 a[40:43], v[112:115], a[164:167], a[40:43]
    ds_read_b64_tr_b16 v[106:107], v12 offset:9216
    v_and_b32 v50, s35, v27
    v_mfma_f32_16x16x32_bf16 a[40:43], a[188:191], a[160:163], a[40:43]
    ds_read_b64_tr_b16 v[92:93], v13 offset:4096
    v_and_b32 v51, s35, v31
    v_mfma_f32_16x16x32_bf16 a[48:51], a[188:191], a[164:167], a[48:51]
    ds_read_b64_tr_b16 v[94:95], v13 offset:5120
    v_add_f32 v48, v48, v49
    v_mfma_f32_16x16x32_bf16 a[48:51], v[112:115], a[168:171], a[48:51]
    ds_read_b64_tr_b16 v[108:109], v13 offset:8192
    v_add_f32 v50, v50, v51
    v_mfma_f32_16x16x32_bf16 a[48:51], v[120:123], a[172:175], a[48:51]
    s_waitcnt lgkmcnt(15)
    ds_read_b64_tr_b16 v[110:111], v13 offset:9216
    v_cvt_pk_bf16_f32 v43, v48, v50
    v_lshlrev_b32 v48, 16, v32
    v_mfma_f32_16x16x32_bf16 a[56:59], v[120:123], a[176:179], a[56:59]
    ds_read_b128 a[104:107], v2 offset:48128
    v_lshlrev_b32 v49, 16, v36
    v_mfma_f32_16x16x32_bf16 a[56:59], v[112:115], a[172:175], a[56:59]
    ds_write_b128 v11, v[40:43] offset:0
    v_and_b32 v50, s35, v32
    v_mfma_f32_16x16x32_bf16 a[56:59], a[188:191], a[168:171], a[56:59]
    ds_read_b128 a[108:111], v8 offset:33792
    v_and_b32 v51, s35, v36
    v_mfma_f32_16x16x32_bf16 a[4:7], a[192:195], a[140:143], a[4:7]
    ds_read_b128 a[112:115], v8 offset:35840
    v_add_f32 v48, v48, v49
    v_mfma_f32_16x16x32_bf16 a[4:7], v[116:119], a[144:147], a[4:7]
    ds_read_b128 a[116:119], v8 offset:37888
    v_add_f32 v50, v50, v51
    v_mfma_f32_16x16x32_bf16 a[4:7], v[124:127], a[148:151], a[4:7]
    ds_read_b128 a[120:123], v8 offset:39936
    v_cvt_pk_bf16_f32 v44, v48, v50
    v_mfma_f32_16x16x32_bf16 a[12:15], v[124:127], a[152:155], a[12:15]
    ds_read_b128 a[124:127], v8 offset:41984
    v_lshlrev_b32 v48, 16, v33
    v_mfma_f32_16x16x32_bf16 a[12:15], v[116:119], a[148:151], a[12:15]
    ds_read_b128 a[128:131], v8 offset:44032
    v_lshlrev_b32 v49, 16, v37
    v_mfma_f32_16x16x32_bf16 a[12:15], a[192:195], a[144:147], a[12:15]
    ds_read_b64_tr_b16 v[80:81], v12 offset:2048
    v_and_b32 v50, s35, v33
    v_mfma_f32_16x16x32_bf16 a[20:23], a[192:195], a[148:151], a[20:23]
    ds_read_b64_tr_b16 v[82:83], v12 offset:3072
    v_and_b32 v51, s35, v37
    v_mfma_f32_16x16x32_bf16 a[20:23], v[116:119], a[152:155], a[20:23]
    ds_read_b64_tr_b16 v[96:97], v12 offset:6144
    v_add_f32 v48, v48, v49
    v_add_f32 v50, v50, v51
    v_mfma_f32_16x16x32_bf16 a[20:23], v[124:127], a[156:159], a[20:23]
    ds_read_b64_tr_b16 v[98:99], v12 offset:7168
    v_cvt_pk_bf16_f32 v45, v48, v50
    v_mfma_f32_16x16x32_bf16 a[28:31], v[124:127], a[160:163], a[28:31]
    ds_read_b64_tr_b16 v[84:85], v13 offset:2048
    v_lshlrev_b32 v48, 16, v34
    v_mfma_f32_16x16x32_bf16 a[28:31], v[116:119], a[156:159], a[28:31]
    ds_read_b64_tr_b16 v[86:87], v13 offset:3072
    v_lshlrev_b32 v49, 16, v38
    v_mfma_f32_16x16x32_bf16 a[28:31], a[192:195], a[152:155], a[28:31]
    ds_read_b64_tr_b16 v[100:101], v13 offset:6144
    v_and_b32 v50, s35, v34
    v_mfma_f32_16x16x32_bf16 a[36:39], a[192:195], a[156:159], a[36:39]
    ds_read_b64_tr_b16 v[102:103], v13 offset:7168
    v_and_b32 v51, s35, v38
    v_mfma_f32_16x16x32_bf16 a[36:39], v[116:119], a[160:163], a[36:39]
    ds_read_b128 a[132:135], v8 offset:46080
    v_add_f32 v48, v48, v49
    v_mfma_f32_16x16x32_bf16 a[36:39], v[124:127], a[164:167], a[36:39]
    ds_read_b128 a[136:139], v8 offset:48128
    v_add_f32 v50, v50, v51
    v_mfma_f32_16x16x32_bf16 a[44:47], v[124:127], a[168:171], a[44:47]
    v_cvt_pk_bf16_f32 v46, v48, v50
    v_lshlrev_b32 v48, 16, v35
    v_mfma_f32_16x16x32_bf16 a[44:47], v[116:119], a[164:167], a[44:47]
    v_lshlrev_b32 v49, 16, v39
    v_and_b32 v50, s35, v35
    v_mfma_f32_16x16x32_bf16 a[44:47], a[192:195], a[160:163], a[44:47]
    v_and_b32 v51, s35, v39
    v_add_f32 v48, v48, v49
    v_mfma_f32_16x16x32_bf16 a[52:55], a[192:195], a[164:167], a[52:55]
    v_add_f32 v50, v50, v51
    v_cvt_pk_bf16_f32 v47, v48, v50
    v_mfma_f32_16x16x32_bf16 a[52:55], v[116:119], a[168:171], a[52:55]
    ds_write_b128 v11, v[44:47] offset:1024
    v_mfma_f32_16x16x32_bf16 a[52:55], v[124:127], a[172:175], a[52:55]
    s_waitcnt lgkmcnt(10)
    v_lshlrev_b32 v52, 16, v80
    v_lshlrev_b32 v53, 16, v88
    v_mfma_f32_16x16x32_bf16 a[60:63], v[124:127], a[176:179], a[60:63]
    v_and_b32 v54, s35, v80
    v_and_b32 v55, s35, v88
    v_mfma_f32_16x16x32_bf16 a[60:63], v[116:119], a[172:175], a[60:63]
    v_add_f32 v52, v52, v53
    v_add_f32 v54, v54, v55
    v_mfma_f32_16x16x32_bf16 a[60:63], a[192:195], a[168:171], a[60:63]
    s_waitcnt lgkmcnt(1)
    v_cvt_pk_bf16_f32 v112, v52, v54
    v_mfma_f32_16x16x32_bf16 v[128:131], a[180:183], a[64:67], v[128:131]
    s_barrier
    v_lshlrev_b32 v52, 16, v81
    v_lshlrev_b32 v53, 16, v89
    v_mfma_f32_16x16x32_bf16 v[128:131], v[88:91], a[68:71], v[128:131]
    s_add_u32 m0, s31, 0
    v_and_b32 v54, s35, v81
    v_and_b32 v55, s35, v89
    v_mfma_f32_16x16x32_bf16 v[128:131], v[104:107], a[72:75], v[128:131]
    buffer_load_dwordx4 v6, s[8:11], s20 offen lds
    v_mfma_f32_16x16x32_bf16 v[136:139], v[104:107], a[76:79], v[136:139]
    v_add_f32 v52, v52, v53
    v_add_f32 v54, v54, v55
    v_mfma_f32_16x16x32_bf16 v[136:139], v[88:91], a[72:75], v[136:139]
    v_cvt_pk_bf16_f32 v113, v52, v54
    v_lshlrev_b32 v52, 16, v82
    v_mfma_f32_16x16x32_bf16 v[136:139], a[180:183], a[68:71], v[136:139]
    v_lshlrev_b32 v53, 16, v90
    v_and_b32 v54, s35, v82
    v_mfma_f32_16x16x32_bf16 v[144:147], a[180:183], a[72:75], v[144:147]
    v_and_b32 v55, s35, v90
    v_add_f32 v52, v52, v53
    v_mfma_f32_16x16x32_bf16 v[144:147], v[88:91], a[76:79], v[144:147]
    v_add_f32 v54, v54, v55
    v_cvt_pk_bf16_f32 v114, v52, v54
    v_mfma_f32_16x16x32_bf16 v[144:147], v[104:107], a[80:83], v[144:147]
    buffer_load_dwordx4 v6, s[8:11], s21 offen offset:1024 lds
    v_mfma_f32_16x16x32_bf16 v[152:155], v[104:107], a[84:87], v[152:155]
    v_lshlrev_b32 v52, 16, v83
    v_lshlrev_b32 v53, 16, v91
    v_mfma_f32_16x16x32_bf16 v[152:155], v[88:91], a[80:83], v[152:155]
    v_and_b32 v54, s35, v83
    v_and_b32 v55, s35, v91
    v_mfma_f32_16x16x32_bf16 v[152:155], a[180:183], a[76:79], v[152:155]
    v_add_f32 v52, v52, v53
    v_add_f32 v54, v54, v55
    v_mfma_f32_16x16x32_bf16 v[160:163], a[180:183], a[80:83], v[160:163]
    v_cvt_pk_bf16_f32 v115, v52, v54
    v_lshlrev_b32 v52, 16, v96
    v_mfma_f32_16x16x32_bf16 v[160:163], v[88:91], a[84:87], v[160:163]
    v_lshlrev_b32 v53, 16, v104
    v_and_b32 v54, s35, v96
    v_mfma_f32_16x16x32_bf16 v[160:163], v[104:107], a[88:91], v[160:163]
    buffer_load_dwordx4 v6, s[8:11], s22 offen offset:2048 lds
    v_mfma_f32_16x16x32_bf16 v[168:171], v[104:107], a[92:95], v[168:171]
    v_and_b32 v55, s35, v104
    v_add_f32 v52, v52, v53
    v_mfma_f32_16x16x32_bf16 v[168:171], v[88:91], a[88:91], v[168:171]
    v_add_f32 v54, v54, v55
    v_cvt_pk_bf16_f32 v120, v52, v54
    v_mfma_f32_16x16x32_bf16 v[168:171], a[180:183], a[84:87], v[168:171]
    v_lshlrev_b32 v52, 16, v97
    v_lshlrev_b32 v53, 16, v105
    v_mfma_f32_16x16x32_bf16 v[176:179], a[180:183], a[88:91], v[176:179]
    v_and_b32 v54, s35, v97
    v_and_b32 v55, s35, v105
    v_mfma_f32_16x16x32_bf16 v[176:179], v[88:91], a[92:95], v[176:179]
    v_add_f32 v52, v52, v53
    v_add_f32 v54, v54, v55
    v_mfma_f32_16x16x32_bf16 v[176:179], v[104:107], a[96:99], v[176:179]
    buffer_load_dwordx4 v6, s[8:11], s23 offen offset:3072 lds
    v_mfma_f32_16x16x32_bf16 v[184:187], v[104:107], a[100:103], v[184:187]
    v_cvt_pk_bf16_f32 v121, v52, v54
    v_lshlrev_b32 v52, 16, v98
    v_mfma_f32_16x16x32_bf16 v[184:187], v[88:91], a[96:99], v[184:187]
    v_lshlrev_b32 v53, 16, v106
    v_and_b32 v54, s35, v98
    v_mfma_f32_16x16x32_bf16 v[184:187], a[180:183], a[92:95], v[184:187]
    v_and_b32 v55, s35, v106
    v_add_f32 v52, v52, v53
    v_mfma_f32_16x16x32_bf16 v[132:135], a[184:187], a[64:67], v[132:135]
    v_add_f32 v54, v54, v55
    v_cvt_pk_bf16_f32 v122, v52, v54
    v_mfma_f32_16x16x32_bf16 v[132:135], v[92:95], a[68:71], v[132:135]
    s_add_u32 m0, s31, 4096
    v_lshlrev_b32 v52, 16, v99
    v_lshlrev_b32 v53, 16, v107
    v_mfma_f32_16x16x32_bf16 v[132:135], v[108:111], a[72:75], v[132:135]
    buffer_load_dwordx4 v6, s[8:11], s24 offen lds
    v_mfma_f32_16x16x32_bf16 v[140:143], v[108:111], a[76:79], v[140:143]
    v_and_b32 v54, s35, v99
    v_and_b32 v55, s35, v107
    v_mfma_f32_16x16x32_bf16 v[140:143], v[92:95], a[72:75], v[140:143]
    v_add_f32 v52, v52, v53
    v_add_f32 v54, v54, v55
    v_mfma_f32_16x16x32_bf16 v[140:143], a[184:187], a[68:71], v[140:143]
    v_cvt_pk_bf16_f32 v123, v52, v54
    v_lshlrev_b32 v52, 16, v84
    v_mfma_f32_16x16x32_bf16 v[148:151], a[184:187], a[72:75], v[148:151]
    v_lshlrev_b32 v53, 16, v92
    v_and_b32 v54, s35, v84
    v_mfma_f32_16x16x32_bf16 v[148:151], v[92:95], a[76:79], v[148:151]
    v_and_b32 v55, s35, v92
    v_add_f32 v52, v52, v53
    v_mfma_f32_16x16x32_bf16 v[148:151], v[108:111], a[80:83], v[148:151]
    buffer_load_dwordx4 v6, s[8:11], s25 offen offset:1024 lds
    v_mfma_f32_16x16x32_bf16 v[156:159], v[108:111], a[84:87], v[156:159]
    v_add_f32 v54, v54, v55
    v_cvt_pk_bf16_f32 v116, v52, v54
    v_mfma_f32_16x16x32_bf16 v[156:159], v[92:95], a[80:83], v[156:159]
    v_lshlrev_b32 v52, 16, v85
    v_lshlrev_b32 v53, 16, v93
    v_mfma_f32_16x16x32_bf16 v[156:159], a[184:187], a[76:79], v[156:159]
    v_and_b32 v54, s35, v85
    v_and_b32 v55, s35, v93
    v_mfma_f32_16x16x32_bf16 v[164:167], a[184:187], a[80:83], v[164:167]
    v_add_f32 v52, v52, v53
    v_add_f32 v54, v54, v55
    v_mfma_f32_16x16x32_bf16 v[164:167], v[92:95], a[84:87], v[164:167]
    v_cvt_pk_bf16_f32 v117, v52, v54
    v_lshlrev_b32 v52, 16, v86
    v_mfma_f32_16x16x32_bf16 v[164:167], v[108:111], a[88:91], v[164:167]
    buffer_load_dwordx4 v6, s[8:11], s26 offen offset:2048 lds
    v_mfma_f32_16x16x32_bf16 v[172:175], v[108:111], a[92:95], v[172:175]
    v_lshlrev_b32 v53, 16, v94
    v_and_b32 v54, s35, v86
    v_mfma_f32_16x16x32_bf16 v[172:175], v[92:95], a[88:91], v[172:175]
    v_and_b32 v55, s35, v94
    v_add_f32 v52, v52, v53
    v_mfma_f32_16x16x32_bf16 v[172:175], a[184:187], a[84:87], v[172:175]
    v_add_f32 v54, v54, v55
    v_cvt_pk_bf16_f32 v118, v52, v54
    v_mfma_f32_16x16x32_bf16 v[180:183], a[184:187], a[88:91], v[180:183]
    v_lshlrev_b32 v52, 16, v87
    v_lshlrev_b32 v53, 16, v95
    v_mfma_f32_16x16x32_bf16 v[180:183], v[92:95], a[92:95], v[180:183]
    v_and_b32 v54, s35, v87
    v_and_b32 v55, s35, v95
    v_mfma_f32_16x16x32_bf16 v[180:183], v[108:111], a[96:99], v[180:183]
    buffer_load_dwordx4 v6, s[8:11], s27 offen offset:3072 lds
    v_mfma_f32_16x16x32_bf16 v[188:191], v[108:111], a[100:103], v[188:191]
    v_add_f32 v52, v52, v53
    v_add_f32 v54, v54, v55
    v_mfma_f32_16x16x32_bf16 v[188:191], v[92:95], a[96:99], v[188:191]
    v_cvt_pk_bf16_f32 v119, v52, v54
    v_lshlrev_b32 v52, 16, v100
    v_mfma_f32_16x16x32_bf16 v[188:191], a[184:187], a[92:95], v[188:191]
    v_lshlrev_b32 v53, 16, v108
    v_and_b32 v54, s35, v100
    v_mfma_f32_16x16x32_bf16 v[192:195], v[80:83], a[104:107], v[192:195]
    v_and_b32 v55, s35, v108
    v_add_f32 v52, v52, v53
    v_mfma_f32_16x16x32_bf16 v[192:195], v[96:99], a[108:111], v[192:195]
    s_add_u32 m0, s31, 8192
    v_add_f32 v54, v54, v55
    v_cvt_pk_bf16_f32 v124, v52, v54
    v_mfma_f32_16x16x32_bf16 v[200:203], v[96:99], a[112:115], v[200:203]
    buffer_load_dwordx4 v6, s[8:11], s28 offen lds
    v_mfma_f32_16x16x32_bf16 v[200:203], v[80:83], a[108:111], v[200:203]
    v_lshlrev_b32 v52, 16, v101
    v_lshlrev_b32 v53, 16, v109
    v_mfma_f32_16x16x32_bf16 v[208:211], v[80:83], a[112:115], v[208:211]
    v_and_b32 v54, s35, v101
    v_and_b32 v55, s35, v109
    v_mfma_f32_16x16x32_bf16 v[208:211], v[96:99], a[116:119], v[208:211]
    v_add_f32 v52, v52, v53
    v_add_f32 v54, v54, v55
    v_mfma_f32_16x16x32_bf16 v[216:219], v[96:99], a[120:123], v[216:219]
    v_cvt_pk_bf16_f32 v125, v52, v54
    v_lshlrev_b32 v52, 16, v102
    v_mfma_f32_16x16x32_bf16 v[216:219], v[80:83], a[116:119], v[216:219]
    v_lshlrev_b32 v53, 16, v110
    v_and_b32 v54, s35, v102
    v_mfma_f32_16x16x32_bf16 v[224:227], v[80:83], a[120:123], v[224:227]
    buffer_load_dwordx4 v6, s[8:11], s29 offen offset:1024 lds
    v_mfma_f32_16x16x32_bf16 v[224:227], v[96:99], a[124:127], v[224:227]
    s_add_u32 s8, s8, 0x10000
    s_addc_u32 s9, s9, 0
    v_and_b32 v55, s35, v110
    v_mfma_f32_16x16x32_bf16 v[232:235], v[96:99], a[128:131], v[232:235]
    s_sub_u32 s10, s10, 0x10000
    v_add_f32 v52, v52, v53
    v_add_f32 v54, v54, v55
    v_mfma_f32_16x16x32_bf16 v[232:235], v[80:83], a[124:127], v[232:235]
    s_waitcnt vmcnt(11) lgkmcnt(0)
    s_barrier
    v_cvt_pk_bf16_f32 v126, v52, v54
    v_mfma_f32_16x16x32_bf16 v[240:243], v[80:83], a[128:131], v[240:243]
    s_add_u32 m0, s30, 16384
    ds_read_b128 v[24:27], v5 offset:32768
    v_lshlrev_b32 v52, 16, v103
    v_mfma_f32_16x16x32_bf16 v[240:243], v[96:99], a[132:135], v[240:243]
    buffer_load_dwordx4 v68, s[4:7], s17 offen lds
    v_mfma_f32_16x16x32_bf16 v[248:251], v[96:99], a[136:139], v[248:251]
    ds_read_b128 v[28:31], v5 offset:33792
    v_lshlrev_b32 v53, 16, v111
    v_mfma_f32_16x16x32_bf16 v[248:251], v[80:83], a[132:135], v[248:251]
    ds_read_b128 v[32:35], v5 offset:34816
    v_and_b32 v54, s35, v103
    v_mfma_f32_16x16x32_bf16 v[196:199], v[84:87], a[104:107], v[196:199]
    ds_read_b128 v[36:39], v5 offset:35840
    v_and_b32 v55, s35, v111
    v_mfma_f32_16x16x32_bf16 v[196:199], v[100:103], a[108:111], v[196:199]
    ds_read_b128 a[140:143], v7 offset:6128
    v_add_f32 v52, v52, v53
    v_mfma_f32_16x16x32_bf16 v[204:207], v[100:103], a[112:115], v[204:207]
    ds_read_b128 a[144:147], v7 offset:7152
    v_add_f32 v54, v54, v55
    v_mfma_f32_16x16x32_bf16 v[204:207], v[84:87], a[108:111], v[204:207]
    buffer_load_dwordx4 v69, s[4:7], s17 offen offset:1024 lds
    v_mfma_f32_16x16x32_bf16 v[212:215], v[84:87], a[112:115], v[212:215]
    ds_read_b128 a[148:151], v7 offset:0
    v_cvt_pk_bf16_f32 v127, v52, v54
    v_mfma_f32_16x16x32_bf16 v[212:215], v[100:103], a[116:119], v[212:215]
    ds_read_b128 a[152:155], v7 offset:1024
    v_mfma_f32_16x16x32_bf16 v[220:223], v[100:103], a[120:123], v[220:223]
    s_waitcnt lgkmcnt(7)
    ds_read_b128 a[156:159], v7 offset:2048
    v_lshlrev_b32 v48, 16, v24
    v_mfma_f32_16x16x32_bf16 v[220:223], v[84:87], a[116:119], v[220:223]
    s_waitcnt lgkmcnt(7)
    ds_read_b128 a[160:163], v7 offset:3072
    v_lshlrev_b32 v49, 16, v28
    v_mfma_f32_16x16x32_bf16 v[228:231], v[84:87], a[120:123], v[228:231]
    ds_read_b128 a[164:167], v7 offset:4096
    v_and_b32 v50, s35, v24
    v_mfma_f32_16x16x32_bf16 v[228:231], v[100:103], a[124:127], v[228:231]
    buffer_load_dwordx4 v70, s[4:7], s17 offen offset:2048 lds
    v_mfma_f32_16x16x32_bf16 v[236:239], v[100:103], a[128:131], v[236:239]
    ds_read_b128 a[168:171], v7 offset:5120
    v_and_b32 v51, s35, v28
    v_mfma_f32_16x16x32_bf16 v[236:239], v[84:87], a[124:127], v[236:239]
    ds_read_b128 a[172:175], v7 offset:6144
    v_add_f32 v48, v48, v49
    v_mfma_f32_16x16x32_bf16 v[244:247], v[84:87], a[128:131], v[244:247]
    ds_read_b128 a[176:179], v7 offset:7168
    v_add_f32 v50, v50, v51
    v_mfma_f32_16x16x32_bf16 v[244:247], v[100:103], a[132:135], v[244:247]
    ds_read_b128 a[64:67], v3 offset:45056
    v_cvt_pk_bf16_f32 v40, v48, v50
    v_mfma_f32_16x16x32_bf16 v[252:255], v[100:103], a[136:139], v[252:255]
    ds_read_b128 a[68:71], v3 offset:47104
    v_lshlrev_b32 v48, 16, v25
    v_mfma_f32_16x16x32_bf16 v[252:255], v[84:87], a[132:135], v[252:255]
    s_waitcnt lgkmcnt(11)
    buffer_load_dwordx4 v71, s[4:7], s17 offen offset:3072 lds
    v_mfma_f32_16x16x32_bf16 a[0:3], a[180:183], a[140:143], a[0:3]
    s_waitcnt lgkmcnt(10)
    s_add_u32 s17, s17, 128
    ds_read_b128 a[72:75], v9 offset:32768
    v_lshlrev_b32 v49, 16, v29
    v_mfma_f32_16x16x32_bf16 a[0:3], v[112:115], a[144:147], a[0:3]
    s_waitcnt lgkmcnt(10)
    ds_read_b128 a[76:79], v9 offset:34816
    v_and_b32 v50, s35, v25
    v_mfma_f32_16x16x32_bf16 a[0:3], v[120:123], a[148:151], a[0:3]
    s_waitcnt lgkmcnt(10)
    buffer_load_dword v23, v14, s[64:67], s68 offen
    v_mfma_f32_16x16x32_bf16 a[8:11], v[120:123], a[152:155], a[8:11]
    s_add_u32 s68, s68, s70
    ds_read_b128 a[80:83], v9 offset:36864
    v_and_b32 v51, s35, v29
    v_mfma_f32_16x16x32_bf16 a[8:11], v[112:115], a[148:151], a[8:11]
    s_min_u32 s68, s68, s71
    ds_read_b128 a[84:87], v9 offset:38912
    v_add_f32 v48, v48, v49
    v_mfma_f32_16x16x32_bf16 a[8:11], a[180:183], a[144:147], a[8:11]
    ds_read_b128 a[88:91], v9 offset:40960
    v_add_f32 v50, v50, v51
    v_mfma_f32_16x16x32_bf16 a[16:19], a[180:183], a[148:151], a[16:19]
    ds_read_b128 a[92:95], v9 offset:43008
    v_cvt_pk_bf16_f32 v41, v48, v50
    v_mfma_f32_16x16x32_bf16 a[16:19], v[112:115], a[152:155], a[16:19]
    s_waitcnt lgkmcnt(13)
    ds_read_b128 a[96:99], v9 offset:45056
    v_lshlrev_b32 v48, 16, v26
    v_mfma_f32_16x16x32_bf16 a[16:19], v[120:123], a[156:159], a[16:19]
    s_waitcnt lgkmcnt(13)
    ds_read_b128 a[100:103], v9 offset:47104
    v_lshlrev_b32 v49, 16, v30
    v_mfma_f32_16x16x32_bf16 a[24:27], v[120:123], a[160:163], a[24:27]
    ds_read_b64_tr_b16 a[188:189], v12 offset:40960
    v_and_b32 v50, s35, v26
    v_mfma_f32_16x16x32_bf16 a[24:27], v[112:115], a[156:159], a[24:27]
    ds_read_b64_tr_b16 a[190:191], v12 offset:41984
    v_and_b32 v51, s35, v30
    v_mfma_f32_16x16x32_bf16 a[24:27], a[180:183], a[152:155], a[24:27]
    ds_read_b64_tr_b16 a[192:193], v13 offset:40960
    v_add_f32 v48, v48, v49
    v_mfma_f32_16x16x32_bf16 a[32:35], a[180:183], a[156:159], a[32:35]
    ds_read_b64_tr_b16 a[194:195], v13 offset:41984
    v_add_f32 v50, v50, v51
    v_mfma_f32_16x16x32_bf16 a[32:35], v[112:115], a[160:163], a[32:35]
    s_waitcnt lgkmcnt(15)
    ds_read_b64_tr_b16 v[88:89], v12 offset:45056
    v_cvt_pk_bf16_f32 v42, v48, v50
    v_mfma_f32_16x16x32_bf16 a[32:35], v[120:123], a[164:167], a[32:35]
    ds_read_b64_tr_b16 v[90:91], v12 offset:46080
    v_lshlrev_b32 v48, 16, v27
    v_mfma_f32_16x16x32_bf16 a[40:43], v[120:123], a[168:171], a[40:43]
    ds_read_b64_tr_b16 v[104:105], v12 offset:49152
    v_lshlrev_b32 v49, 16, v31
    v_mfma_f32_16x16x32_bf16 a[40:43], v[112:115], a[164:167], a[40:43]
    ds_read_b64_tr_b16 v[106:107], v12 offset:50176
    v_and_b32 v50, s35, v27
    v_mfma_f32_16x16x32_bf16 a[40:43], a[180:183], a[160:163], a[40:43]
    ds_read_b64_tr_b16 v[92:93], v13 offset:45056
    v_and_b32 v51, s35, v31
    v_mfma_f32_16x16x32_bf16 a[48:51], a[180:183], a[164:167], a[48:51]
    ds_read_b64_tr_b16 v[94:95], v13 offset:46080
    v_add_f32 v48, v48, v49
    v_mfma_f32_16x16x32_bf16 a[48:51], v[112:115], a[168:171], a[48:51]
    ds_read_b64_tr_b16 v[108:109], v13 offset:49152
    v_add_f32 v50, v50, v51
    v_mfma_f32_16x16x32_bf16 a[48:51], v[120:123], a[172:175], a[48:51]
    s_waitcnt lgkmcnt(15)
    ds_read_b64_tr_b16 v[110:111], v13 offset:50176
    v_cvt_pk_bf16_f32 v43, v48, v50
    v_lshlrev_b32 v48, 16, v32
    v_mfma_f32_16x16x32_bf16 a[56:59], v[120:123], a[176:179], a[56:59]
    ds_read_b128 a[104:107], v3 offset:48128
    v_lshlrev_b32 v49, 16, v36
    v_mfma_f32_16x16x32_bf16 a[56:59], v[112:115], a[172:175], a[56:59]
    ds_write_b128 v11, v[40:43] offset:8192
    v_and_b32 v50, s35, v32
    v_mfma_f32_16x16x32_bf16 a[56:59], a[180:183], a[168:171], a[56:59]
    ds_read_b128 a[108:111], v9 offset:33792
    v_and_b32 v51, s35, v36
    v_mfma_f32_16x16x32_bf16 a[4:7], a[184:187], a[140:143], a[4:7]
    ds_read_b128 a[112:115], v9 offset:35840
    v_add_f32 v48, v48, v49
    v_mfma_f32_16x16x32_bf16 a[4:7], v[116:119], a[144:147], a[4:7]
    ds_read_b128 a[116:119], v9 offset:37888
    v_add_f32 v50, v50, v51
    v_mfma_f32_16x16x32_bf16 a[4:7], v[124:127], a[148:151], a[4:7]
    ds_read_b128 a[120:123], v9 offset:39936
    v_cvt_pk_bf16_f32 v44, v48, v50
    v_mfma_f32_16x16x32_bf16 a[12:15], v[124:127], a[152:155], a[12:15]
    ds_read_b128 a[124:127], v9 offset:41984
    v_lshlrev_b32 v48, 16, v33
    v_mfma_f32_16x16x32_bf16 a[12:15], v[116:119], a[148:151], a[12:15]
    ds_read_b128 a[128:131], v9 offset:44032
    v_lshlrev_b32 v49, 16, v37
    v_mfma_f32_16x16x32_bf16 a[12:15], a[184:187], a[144:147], a[12:15]
    ds_read_b64_tr_b16 v[80:81], v12 offset:43008
    v_and_b32 v50, s35, v33
    v_mfma_f32_16x16x32_bf16 a[20:23], a[184:187], a[148:151], a[20:23]
    ds_read_b64_tr_b16 v[82:83], v12 offset:44032
    v_and_b32 v51, s35, v37
    v_mfma_f32_16x16x32_bf16 a[20:23], v[116:119], a[152:155], a[20:23]
    ds_read_b64_tr_b16 v[96:97], v12 offset:47104
    v_add_f32 v48, v48, v49
    v_add_f32 v50, v50, v51
    v_mfma_f32_16x16x32_bf16 a[20:23], v[124:127], a[156:159], a[20:23]
    ds_read_b64_tr_b16 v[98:99], v12 offset:48128
    v_cvt_pk_bf16_f32 v45, v48, v50
    v_mfma_f32_16x16x32_bf16 a[28:31], v[124:127], a[160:163], a[28:31]
    ds_read_b64_tr_b16 v[84:85], v13 offset:43008
    v_lshlrev_b32 v48, 16, v34
    v_mfma_f32_16x16x32_bf16 a[28:31], v[116:119], a[156:159], a[28:31]
    ds_read_b64_tr_b16 v[86:87], v13 offset:44032
    v_lshlrev_b32 v49, 16, v38
    v_mfma_f32_16x16x32_bf16 a[28:31], a[184:187], a[152:155], a[28:31]
    ds_read_b64_tr_b16 v[100:101], v13 offset:47104
    v_and_b32 v50, s35, v34
    v_mfma_f32_16x16x32_bf16 a[36:39], a[184:187], a[156:159], a[36:39]
    ds_read_b64_tr_b16 v[102:103], v13 offset:48128
    v_and_b32 v51, s35, v38
    v_mfma_f32_16x16x32_bf16 a[36:39], v[116:119], a[160:163], a[36:39]
    ds_read_b128 a[132:135], v9 offset:46080
    v_add_f32 v48, v48, v49
    v_mfma_f32_16x16x32_bf16 a[36:39], v[124:127], a[164:167], a[36:39]
    ds_read_b128 a[136:139], v9 offset:48128
    v_add_f32 v50, v50, v51
    v_mfma_f32_16x16x32_bf16 a[44:47], v[124:127], a[168:171], a[44:47]
    v_cvt_pk_bf16_f32 v46, v48, v50
    v_lshlrev_b32 v48, 16, v35
    v_mfma_f32_16x16x32_bf16 a[44:47], v[116:119], a[164:167], a[44:47]
    v_lshlrev_b32 v49, 16, v39
    v_and_b32 v50, s35, v35
    v_mfma_f32_16x16x32_bf16 a[44:47], a[184:187], a[160:163], a[44:47]
    v_and_b32 v51, s35, v39
    v_add_f32 v48, v48, v49
    v_mfma_f32_16x16x32_bf16 a[52:55], a[184:187], a[164:167], a[52:55]
    v_add_f32 v50, v50, v51
    v_cvt_pk_bf16_f32 v47, v48, v50
    v_mfma_f32_16x16x32_bf16 a[52:55], v[116:119], a[168:171], a[52:55]
    ds_write_b128 v11, v[44:47] offset:9216
    v_mfma_f32_16x16x32_bf16 a[52:55], v[124:127], a[172:175], a[52:55]
    s_waitcnt lgkmcnt(10)
    v_lshlrev_b32 v52, 16, v80
    v_lshlrev_b32 v53, 16, v88
    v_mfma_f32_16x16x32_bf16 a[60:63], v[124:127], a[176:179], a[60:63]
    v_and_b32 v54, s35, v80
    v_and_b32 v55, s35, v88
    v_mfma_f32_16x16x32_bf16 a[60:63], v[116:119], a[172:175], a[60:63]
    v_add_f32 v52, v52, v53
    v_add_f32 v54, v54, v55
    v_mfma_f32_16x16x32_bf16 a[60:63], a[184:187], a[168:171], a[60:63]
    s_waitcnt lgkmcnt(1)
    v_cvt_pk_bf16_f32 v112, v52, v54
    v_mfma_f32_16x16x32_bf16 v[128:131], a[188:191], a[64:67], v[128:131]
    s_barrier
    v_lshlrev_b32 v52, 16, v81
    v_lshlrev_b32 v53, 16, v89
    v_mfma_f32_16x16x32_bf16 v[128:131], v[88:91], a[68:71], v[128:131]
    s_add_u32 m0, s31, 40960
    v_and_b32 v54, s35, v81
    v_and_b32 v55, s35, v89
    v_mfma_f32_16x16x32_bf16 v[128:131], v[104:107], a[72:75], v[128:131]
    buffer_load_dwordx4 v6, s[8:11], s20 offen lds
    v_mfma_f32_16x16x32_bf16 v[136:139], v[104:107], a[76:79], v[136:139]
    v_add_f32 v52, v52, v53
    v_add_f32 v54, v54, v55
    v_mfma_f32_16x16x32_bf16 v[136:139], v[88:91], a[72:75], v[136:139]
    v_cvt_pk_bf16_f32 v113, v52, v54
    v_lshlrev_b32 v52, 16, v82
    v_mfma_f32_16x16x32_bf16 v[136:139], a[188:191], a[68:71], v[136:139]
    v_lshlrev_b32 v53, 16, v90
    v_and_b32 v54, s35, v82
    v_mfma_f32_16x16x32_bf16 v[144:147], a[188:191], a[72:75], v[144:147]
    v_and_b32 v55, s35, v90
    v_add_f32 v52, v52, v53
    v_mfma_f32_16x16x32_bf16 v[144:147], v[88:91], a[76:79], v[144:147]
    v_add_f32 v54, v54, v55
    v_cvt_pk_bf16_f32 v114, v52, v54
    v_mfma_f32_16x16x32_bf16 v[144:147], v[104:107], a[80:83], v[144:147]
    buffer_load_dwordx4 v6, s[8:11], s21 offen offset:1024 lds
    v_mfma_f32_16x16x32_bf16 v[152:155], v[104:107], a[84:87], v[152:155]
    v_lshlrev_b32 v52, 16, v83
    v_lshlrev_b32 v53, 16, v91
    v_mfma_f32_16x16x32_bf16 v[152:155], v[88:91], a[80:83], v[152:155]
    v_and_b32 v54, s35, v83
    v_and_b32 v55, s35, v91
    v_mfma_f32_16x16x32_bf16 v[152:155], a[188:191], a[76:79], v[152:155]
    v_add_f32 v52, v52, v53
    v_add_f32 v54, v54, v55
    v_mfma_f32_16x16x32_bf16 v[160:163], a[188:191], a[80:83], v[160:163]
    v_cvt_pk_bf16_f32 v115, v52, v54
    v_lshlrev_b32 v52, 16, v96
    v_mfma_f32_16x16x32_bf16 v[160:163], v[88:91], a[84:87], v[160:163]
    v_lshlrev_b32 v53, 16, v104
    v_and_b32 v54, s35, v96
    v_mfma_f32_16x16x32_bf16 v[160:163], v[104:107], a[88:91], v[160:163]
    buffer_load_dwordx4 v6, s[8:11], s22 offen offset:2048 lds
    v_mfma_f32_16x16x32_bf16 v[168:171], v[104:107], a[92:95], v[168:171]
    v_and_b32 v55, s35, v104
    v_add_f32 v52, v52, v53
    v_mfma_f32_16x16x32_bf16 v[168:171], v[88:91], a[88:91], v[168:171]
    v_add_f32 v54, v54, v55
    v_cvt_pk_bf16_f32 v120, v52, v54
    v_mfma_f32_16x16x32_bf16 v[168:171], a[188:191], a[84:87], v[168:171]
    v_lshlrev_b32 v52, 16, v97
    v_lshlrev_b32 v53, 16, v105
    v_mfma_f32_16x16x32_bf16 v[176:179], a[188:191], a[88:91], v[176:179]
    v_and_b32 v54, s35, v97
    v_and_b32 v55, s35, v105
    v_mfma_f32_16x16x32_bf16 v[176:179], v[88:91], a[92:95], v[176:179]
    v_add_f32 v52, v52, v53
    v_add_f32 v54, v54, v55
    v_mfma_f32_16x16x32_bf16 v[176:179], v[104:107], a[96:99], v[176:179]
    buffer_load_dwordx4 v6, s[8:11], s23 offen offset:3072 lds
    v_mfma_f32_16x16x32_bf16 v[184:187], v[104:107], a[100:103], v[184:187]
    v_cvt_pk_bf16_f32 v121, v52, v54
    v_lshlrev_b32 v52, 16, v98
    v_mfma_f32_16x16x32_bf16 v[184:187], v[88:91], a[96:99], v[184:187]
    v_lshlrev_b32 v53, 16, v106
    v_and_b32 v54, s35, v98
    v_mfma_f32_16x16x32_bf16 v[184:187], a[188:191], a[92:95], v[184:187]
    v_and_b32 v55, s35, v106
    v_add_f32 v52, v52, v53
    v_mfma_f32_16x16x32_bf16 v[132:135], a[192:195], a[64:67], v[132:135]
    v_add_f32 v54, v54, v55
    v_cvt_pk_bf16_f32 v122, v52, v54
    v_mfma_f32_16x16x32_bf16 v[132:135], v[92:95], a[68:71], v[132:135]
    s_add_u32 m0, s31, 45056
    v_lshlrev_b32 v52, 16, v99
    v_lshlrev_b32 v53, 16, v107
    v_mfma_f32_16x16x32_bf16 v[132:135], v[108:111], a[72:75], v[132:135]
    buffer_load_dwordx4 v6, s[8:11], s24 offen lds
    v_mfma_f32_16x16x32_bf16 v[140:143], v[108:111], a[76:79], v[140:143]
    v_and_b32 v54, s35, v99
    v_and_b32 v55, s35, v107
    v_mfma_f32_16x16x32_bf16 v[140:143], v[92:95], a[72:75], v[140:143]
    v_add_f32 v52, v52, v53
    v_add_f32 v54, v54, v55
    v_mfma_f32_16x16x32_bf16 v[140:143], a[192:195], a[68:71], v[140:143]
    v_cvt_pk_bf16_f32 v123, v52, v54
    v_lshlrev_b32 v52, 16, v84
    v_mfma_f32_16x16x32_bf16 v[148:151], a[192:195], a[72:75], v[148:151]
    v_lshlrev_b32 v53, 16, v92
    v_and_b32 v54, s35, v84
    v_mfma_f32_16x16x32_bf16 v[148:151], v[92:95], a[76:79], v[148:151]
    v_and_b32 v55, s35, v92
    v_add_f32 v52, v52, v53
    v_mfma_f32_16x16x32_bf16 v[148:151], v[108:111], a[80:83], v[148:151]
    buffer_load_dwordx4 v6, s[8:11], s25 offen offset:1024 lds
    v_mfma_f32_16x16x32_bf16 v[156:159], v[108:111], a[84:87], v[156:159]
    v_add_f32 v54, v54, v55
    v_cvt_pk_bf16_f32 v116, v52, v54
    v_mfma_f32_16x16x32_bf16 v[156:159], v[92:95], a[80:83], v[156:159]
    v_lshlrev_b32 v52, 16, v85
    v_lshlrev_b32 v53, 16, v93
    v_mfma_f32_16x16x32_bf16 v[156:159], a[192:195], a[76:79], v[156:159]
    v_and_b32 v54, s35, v85
    v_and_b32 v55, s35, v93
    v_mfma_f32_16x16x32_bf16 v[164:167], a[192:195], a[80:83], v[164:167]
    v_add_f32 v52, v52, v53
    v_add_f32 v54, v54, v55
    v_mfma_f32_16x16x32_bf16 v[164:167], v[92:95], a[84:87], v[164:167]
    v_cvt_pk_bf16_f32 v117, v52, v54
    v_lshlrev_b32 v52, 16, v86
    v_mfma_f32_16x16x32_bf16 v[164:167], v[108:111], a[88:91], v[164:167]
    buffer_load_dwordx4 v6, s[8:11], s26 offen offset:2048 lds
    v_mfma_f32_16x16x32_bf16 v[172:175], v[108:111], a[92:95], v[172:175]
    v_lshlrev_b32 v53, 16, v94
    v_and_b32 v54, s35, v86
    v_mfma_f32_16x16x32_bf16 v[172:175], v[92:95], a[88:91], v[172:175]
    v_and_b32 v55, s35, v94
    v_add_f32 v52, v52, v53
    v_mfma_f32_16x16x32_bf16 v[172:175], a[192:195], a[84:87], v[172:175]
    v_add_f32 v54, v54, v55
    v_cvt_pk_bf16_f32 v118, v52, v54
    v_mfma_f32_16x16x32_bf16 v[180:183], a[192:195], a[88:91], v[180:183]
    v_lshlrev_b32 v52, 16, v87
    v_lshlrev_b32 v53, 16, v95
    v_mfma_f32_16x16x32_bf16 v[180:183], v[92:95], a[92:95], v[180:183]
    v_and_b32 v54, s35, v87
    v_and_b32 v55, s35, v95
    v_mfma_f32_16x16x32_bf16 v[180:183], v[108:111], a[96:99], v[180:183]
    buffer_load_dwordx4 v6, s[8:11], s27 offen offset:3072 lds
    v_mfma_f32_16x16x32_bf16 v[188:191], v[108:111], a[100:103], v[188:191]
    v_add_f32 v52, v52, v53
    v_add_f32 v54, v54, v55
    v_mfma_f32_16x16x32_bf16 v[188:191], v[92:95], a[96:99], v[188:191]
    v_cvt_pk_bf16_f32 v119, v52, v54
    v_lshlrev_b32 v52, 16, v100
    v_mfma_f32_16x16x32_bf16 v[188:191], a[192:195], a[92:95], v[188:191]
    v_lshlrev_b32 v53, 16, v108
    v_and_b32 v54, s35, v100
    v_mfma_f32_16x16x32_bf16 v[192:195], v[80:83], a[104:107], v[192:195]
    v_and_b32 v55, s35, v108
    v_add_f32 v52, v52, v53
    v_mfma_f32_16x16x32_bf16 v[192:195], v[96:99], a[108:111], v[192:195]
    s_add_u32 m0, s31, 49152
    v_add_f32 v54, v54, v55
    v_cvt_pk_bf16_f32 v124, v52, v54
    v_mfma_f32_16x16x32_bf16 v[200:203], v[96:99], a[112:115], v[200:203]
    buffer_load_dwordx4 v6, s[8:11], s28 offen lds
    v_mfma_f32_16x16x32_bf16 v[200:203], v[80:83], a[108:111], v[200:203]
    v_lshlrev_b32 v52, 16, v101
    v_lshlrev_b32 v53, 16, v109
    v_mfma_f32_16x16x32_bf16 v[208:211], v[80:83], a[112:115], v[208:211]
    v_and_b32 v54, s35, v101
    v_and_b32 v55, s35, v109
    v_mfma_f32_16x16x32_bf16 v[208:211], v[96:99], a[116:119], v[208:211]
    v_add_f32 v52, v52, v53
    v_add_f32 v54, v54, v55
    v_mfma_f32_16x16x32_bf16 v[216:219], v[96:99], a[120:123], v[216:219]
    v_cvt_pk_bf16_f32 v125, v52, v54
    v_lshlrev_b32 v52, 16, v102
    v_mfma_f32_16x16x32_bf16 v[216:219], v[80:83], a[116:119], v[216:219]
    v_lshlrev_b32 v53, 16, v110
    v_and_b32 v54, s35, v102
    v_mfma_f32_16x16x32_bf16 v[224:227], v[80:83], a[120:123], v[224:227]
    buffer_load_dwordx4 v6, s[8:11], s29 offen offset:1024 lds
    v_mfma_f32_16x16x32_bf16 v[224:227], v[96:99], a[124:127], v[224:227]
    s_add_u32 s8, s8, 0x10000
    s_addc_u32 s9, s9, 0
    v_and_b32 v55, s35, v110
    v_mfma_f32_16x16x32_bf16 v[232:235], v[96:99], a[128:131], v[232:235]
    s_sub_u32 s10, s10, 0x10000
    v_add_f32 v52, v52, v53
    v_add_f32 v54, v54, v55
    v_mfma_f32_16x16x32_bf16 v[232:235], v[80:83], a[124:127], v[232:235]
    s_waitcnt vmcnt(11) lgkmcnt(0)
    s_barrier
    v_cvt_pk_bf16_f32 v126, v52, v54
    v_mfma_f32_16x16x32_bf16 v[240:243], v[80:83], a[128:131], v[240:243]
    s_add_u32 m0, s30, 32768
    ds_read_b128 v[24:27], v4 offset:0
    v_lshlrev_b32 v52, 16, v103
    v_mfma_f32_16x16x32_bf16 v[240:243], v[96:99], a[132:135], v[240:243]
    buffer_load_dwordx4 v64, s[4:7], s17 offen lds
    v_mfma_f32_16x16x32_bf16 v[248:251], v[96:99], a[136:139], v[248:251]
    ds_read_b128 v[28:31], v4 offset:1024
    v_lshlrev_b32 v53, 16, v111
    v_mfma_f32_16x16x32_bf16 v[248:251], v[80:83], a[132:135], v[248:251]
    ds_read_b128 v[32:35], v4 offset:2048
    v_and_b32 v54, s35, v103
    v_mfma_f32_16x16x32_bf16 v[196:199], v[84:87], a[104:107], v[196:199]
    ds_read_b128 v[36:39], v4 offset:3072
    v_and_b32 v55, s35, v111
    v_mfma_f32_16x16x32_bf16 v[196:199], v[100:103], a[108:111], v[196:199]
    ds_read_b128 a[140:143], v7 offset:14320
    v_add_f32 v52, v52, v53
    v_mfma_f32_16x16x32_bf16 v[204:207], v[100:103], a[112:115], v[204:207]
    ds_read_b128 a[144:147], v7 offset:15344
    v_add_f32 v54, v54, v55
    v_mfma_f32_16x16x32_bf16 v[204:207], v[84:87], a[108:111], v[204:207]
    buffer_load_dwordx4 v65, s[4:7], s17 offen offset:1024 lds
    v_mfma_f32_16x16x32_bf16 v[212:215], v[84:87], a[112:115], v[212:215]
    ds_read_b128 a[148:151], v7 offset:8192
    v_cvt_pk_bf16_f32 v127, v52, v54
    v_mfma_f32_16x16x32_bf16 v[212:215], v[100:103], a[116:119], v[212:215]
    ds_read_b128 a[152:155], v7 offset:9216
    v_mfma_f32_16x16x32_bf16 v[220:223], v[100:103], a[120:123], v[220:223]
    s_waitcnt lgkmcnt(7)
    ds_read_b128 a[156:159], v7 offset:10240
    v_lshlrev_b32 v48, 16, v24
    v_mfma_f32_16x16x32_bf16 v[220:223], v[84:87], a[116:119], v[220:223]
    s_waitcnt lgkmcnt(7)
    ds_read_b128 a[160:163], v7 offset:11264
    v_lshlrev_b32 v49, 16, v28
    v_mfma_f32_16x16x32_bf16 v[228:231], v[84:87], a[120:123], v[228:231]
    ds_read_b128 a[164:167], v7 offset:12288
    v_and_b32 v50, s35, v24
    v_mfma_f32_16x16x32_bf16 v[228:231], v[100:103], a[124:127], v[228:231]
    buffer_load_dwordx4 v66, s[4:7], s17 offen offset:2048 lds
    v_mfma_f32_16x16x32_bf16 v[236:239], v[100:103], a[128:131], v[236:239]
    ds_read_b128 a[168:171], v7 offset:13312
    v_and_b32 v51, s35, v28
    v_mfma_f32_16x16x32_bf16 v[236:239], v[84:87], a[124:127], v[236:239]
    ds_read_b128 a[172:175], v7 offset:14336
    v_add_f32 v48, v48, v49
    v_mfma_f32_16x16x32_bf16 v[244:247], v[84:87], a[128:131], v[244:247]
    ds_read_b128 a[176:179], v7 offset:15360
    v_add_f32 v50, v50, v51
    v_mfma_f32_16x16x32_bf16 v[244:247], v[100:103], a[132:135], v[244:247]
    ds_read_b128 a[64:67], v2 offset:12288
    v_cvt_pk_bf16_f32 v40, v48, v50
    v_mfma_f32_16x16x32_bf16 v[252:255], v[100:103], a[136:139], v[252:255]
    ds_read_b128 a[68:71], v2 offset:14336
    v_lshlrev_b32 v48, 16, v25
    v_mfma_f32_16x16x32_bf16 v[252:255], v[84:87], a[132:135], v[252:255]
    s_waitcnt lgkmcnt(11)
    buffer_load_dwordx4 v67, s[4:7], s17 offen offset:3072 lds
    v_mfma_f32_16x16x32_bf16 a[0:3], a[188:191], a[140:143], a[0:3]
    s_waitcnt lgkmcnt(10)
    ds_read_b128 a[72:75], v8 offset:0
    v_lshlrev_b32 v49, 16, v29
    v_mfma_f32_16x16x32_bf16 a[0:3], v[112:115], a[144:147], a[0:3]
    s_waitcnt lgkmcnt(10)
    ds_read_b128 a[76:79], v8 offset:2048
    v_and_b32 v50, s35, v25
    v_mfma_f32_16x16x32_bf16 a[0:3], v[120:123], a[148:151], a[0:3]
    s_waitcnt lgkmcnt(10)
    buffer_load_dword v23, v15, s[64:67], s68 offen
    v_mfma_f32_16x16x32_bf16 a[8:11], v[120:123], a[152:155], a[8:11]
    s_add_u32 s68, s68, s69
    ds_read_b128 a[80:83], v8 offset:4096
    v_and_b32 v51, s35, v29
    v_mfma_f32_16x16x32_bf16 a[8:11], v[112:115], a[148:151], a[8:11]
    s_min_u32 s68, s68, s71
    ds_read_b128 a[84:87], v8 offset:6144
    v_add_f32 v48, v48, v49
    v_mfma_f32_16x16x32_bf16 a[8:11], a[188:191], a[144:147], a[8:11]
    ds_read_b128 a[88:91], v8 offset:8192
    v_add_f32 v50, v50, v51
    v_mfma_f32_16x16x32_bf16 a[16:19], a[188:191], a[148:151], a[16:19]
    ds_read_b128 a[92:95], v8 offset:10240
    v_cvt_pk_bf16_f32 v41, v48, v50
    v_mfma_f32_16x16x32_bf16 a[16:19], v[112:115], a[152:155], a[16:19]
    s_waitcnt lgkmcnt(13)
    ds_read_b128 a[96:99], v8 offset:12288
    v_lshlrev_b32 v48, 16, v26
    v_mfma_f32_16x16x32_bf16 a[16:19], v[120:123], a[156:159], a[16:19]
    s_waitcnt lgkmcnt(13)
    ds_read_b128 a[100:103], v8 offset:14336
    v_lshlrev_b32 v49, 16, v30
    v_mfma_f32_16x16x32_bf16 a[24:27], v[120:123], a[160:163], a[24:27]
    ds_read_b64_tr_b16 a[180:181], v12 offset:0
    v_and_b32 v50, s35, v26
    v_mfma_f32_16x16x32_bf16 a[24:27], v[112:115], a[156:159], a[24:27]
    ds_read_b64_tr_b16 a[182:183], v12 offset:1024
    v_and_b32 v51, s35, v30
    v_mfma_f32_16x16x32_bf16 a[24:27], a[188:191], a[152:155], a[24:27]
    ds_read_b64_tr_b16 a[184:185], v13 offset:0
    v_add_f32 v48, v48, v49
    v_mfma_f32_16x16x32_bf16 a[32:35], a[188:191], a[156:159], a[32:35]
    ds_read_b64_tr_b16 a[186:187], v13 offset:1024
    v_add_f32 v50, v50, v51
    v_mfma_f32_16x16x32_bf16 a[32:35], v[112:115], a[160:163], a[32:35]
    s_waitcnt lgkmcnt(15)
    ds_read_b64_tr_b16 v[88:89], v12 offset:4096
    v_cvt_pk_bf16_f32 v42, v48, v50
    v_mfma_f32_16x16x32_bf16 a[32:35], v[120:123], a[164:167], a[32:35]
    ds_read_b64_tr_b16 v[90:91], v12 offset:5120
    v_lshlrev_b32 v48, 16, v27
    v_mfma_f32_16x16x32_bf16 a[40:43], v[120:123], a[168:171], a[40:43]
    ds_read_b64_tr_b16 v[104:105], v12 offset:8192
    v_lshlrev_b32 v49, 16, v31
    v_mfma_f32_16x16x32_bf16 a[40:43], v[112:115], a[164:167], a[40:43]
    ds_read_b64_tr_b16 v[106:107], v12 offset:9216
    v_and_b32 v50, s35, v27
    v_mfma_f32_16x16x32_bf16 a[40:43], a[188:191], a[160:163], a[40:43]
    ds_read_b64_tr_b16 v[92:93], v13 offset:4096
    v_and_b32 v51, s35, v31
    v_mfma_f32_16x16x32_bf16 a[48:51], a[188:191], a[164:167], a[48:51]
    ds_read_b64_tr_b16 v[94:95], v13 offset:5120
    v_add_f32 v48, v48, v49
    v_mfma_f32_16x16x32_bf16 a[48:51], v[112:115], a[168:171], a[48:51]
    ds_read_b64_tr_b16 v[108:109], v13 offset:8192
    v_add_f32 v50, v50, v51
    v_mfma_f32_16x16x32_bf16 a[48:51], v[120:123], a[172:175], a[48:51]
    s_waitcnt lgkmcnt(15)
    ds_read_b64_tr_b16 v[110:111], v13 offset:9216
    v_cvt_pk_bf16_f32 v43, v48, v50
    v_lshlrev_b32 v48, 16, v32
    v_mfma_f32_16x16x32_bf16 a[56:59], v[120:123], a[176:179], a[56:59]
    ds_read_b128 a[104:107], v2 offset:15360
    v_lshlrev_b32 v49, 16, v36
    v_mfma_f32_16x16x32_bf16 a[56:59], v[112:115], a[172:175], a[56:59]
    ds_write_b128 v11, v[40:43] offset:0
    v_and_b32 v50, s35, v32
    v_mfma_f32_16x16x32_bf16 a[56:59], a[188:191], a[168:171], a[56:59]
    ds_read_b128 a[108:111], v8 offset:1024
    v_and_b32 v51, s35, v36
    v_mfma_f32_16x16x32_bf16 a[4:7], a[192:195], a[140:143], a[4:7]
    ds_read_b128 a[112:115], v8 offset:3072
    v_add_f32 v48, v48, v49
    v_mfma_f32_16x16x32_bf16 a[4:7], v[116:119], a[144:147], a[4:7]
    ds_read_b128 a[116:119], v8 offset:5120
    v_add_f32 v50, v50, v51
    v_mfma_f32_16x16x32_bf16 a[4:7], v[124:127], a[148:151], a[4:7]
    ds_read_b128 a[120:123], v8 offset:7168
    v_cvt_pk_bf16_f32 v44, v48, v50
    v_mfma_f32_16x16x32_bf16 a[12:15], v[124:127], a[152:155], a[12:15]
    ds_read_b128 a[124:127], v8 offset:9216
    v_lshlrev_b32 v48, 16, v33
    v_mfma_f32_16x16x32_bf16 a[12:15], v[116:119], a[148:151], a[12:15]
    ds_read_b128 a[128:131], v8 offset:11264
    v_lshlrev_b32 v49, 16, v37
    v_mfma_f32_16x16x32_bf16 a[12:15], a[192:195], a[144:147], a[12:15]
    ds_read_b64_tr_b16 v[80:81], v12 offset:2048
    v_and_b32 v50, s35, v33
    v_mfma_f32_16x16x32_bf16 a[20:23], a[192:195], a[148:151], a[20:23]
    ds_read_b64_tr_b16 v[82:83], v12 offset:3072
    v_and_b32 v51, s35, v37
    v_mfma_f32_16x16x32_bf16 a[20:23], v[116:119], a[152:155], a[20:23]
    ds_read_b64_tr_b16 v[96:97], v12 offset:6144
    v_add_f32 v48, v48, v49
    v_add_f32 v50, v50, v51
    v_mfma_f32_16x16x32_bf16 a[20:23], v[124:127], a[156:159], a[20:23]
    ds_read_b64_tr_b16 v[98:99], v12 offset:7168
    v_cvt_pk_bf16_f32 v45, v48, v50
    v_mfma_f32_16x16x32_bf16 a[28:31], v[124:127], a[160:163], a[28:31]
    ds_read_b64_tr_b16 v[84:85], v13 offset:2048
    v_lshlrev_b32 v48, 16, v34
    v_mfma_f32_16x16x32_bf16 a[28:31], v[116:119], a[156:159], a[28:31]
    ds_read_b64_tr_b16 v[86:87], v13 offset:3072
    v_lshlrev_b32 v49, 16, v38
    v_mfma_f32_16x16x32_bf16 a[28:31], a[192:195], a[152:155], a[28:31]
    ds_read_b64_tr_b16 v[100:101], v13 offset:6144
    v_and_b32 v50, s35, v34
    v_mfma_f32_16x16x32_bf16 a[36:39], a[192:195], a[156:159], a[36:39]
    ds_read_b64_tr_b16 v[102:103], v13 offset:7168
    v_and_b32 v51, s35, v38
    v_mfma_f32_16x16x32_bf16 a[36:39], v[116:119], a[160:163], a[36:39]
    ds_read_b128 a[132:135], v8 offset:13312
    v_add_f32 v48, v48, v49
    v_mfma_f32_16x16x32_bf16 a[36:39], v[124:127], a[164:167], a[36:39]
    ds_read_b128 a[136:139], v8 offset:15360
    v_add_f32 v50, v50, v51
    v_mfma_f32_16x16x32_bf16 a[44:47], v[124:127], a[168:171], a[44:47]
    v_cvt_pk_bf16_f32 v46, v48, v50
    v_lshlrev_b32 v48, 16, v35
    v_mfma_f32_16x16x32_bf16 a[44:47], v[116:119], a[164:167], a[44:47]
    v_lshlrev_b32 v49, 16, v39
    v_and_b32 v50, s35, v35
    v_mfma_f32_16x16x32_bf16 a[44:47], a[192:195], a[160:163], a[44:47]
    v_and_b32 v51, s35, v39
    v_add_f32 v48, v48, v49
    v_mfma_f32_16x16x32_bf16 a[52:55], a[192:195], a[164:167], a[52:55]
    v_add_f32 v50, v50, v51
    v_cvt_pk_bf16_f32 v47, v48, v50
    v_mfma_f32_16x16x32_bf16 a[52:55], v[116:119], a[168:171], a[52:55]
    ds_write_b128 v11, v[44:47] offset:1024
    v_mfma_f32_16x16x32_bf16 a[52:55], v[124:127], a[172:175], a[52:55]
    s_waitcnt lgkmcnt(10)
    v_lshlrev_b32 v52, 16, v80
    v_lshlrev_b32 v53, 16, v88
    v_mfma_f32_16x16x32_bf16 a[60:63], v[124:127], a[176:179], a[60:63]
    v_and_b32 v54, s35, v80
    v_and_b32 v55, s35, v88
    v_mfma_f32_16x16x32_bf16 a[60:63], v[116:119], a[172:175], a[60:63]
    v_add_f32 v52, v52, v53
    v_add_f32 v54, v54, v55
    v_mfma_f32_16x16x32_bf16 a[60:63], a[192:195], a[168:171], a[60:63]
    s_waitcnt lgkmcnt(1)
    v_cvt_pk_bf16_f32 v112, v52, v54
    v_mfma_f32_16x16x32_bf16 v[128:131], a[180:183], a[64:67], v[128:131]
    s_barrier
    v_lshlrev_b32 v52, 16, v81
    v_lshlrev_b32 v53, 16, v89
    v_mfma_f32_16x16x32_bf16 v[128:131], v[88:91], a[68:71], v[128:131]
    s_add_u32 m0, s31, 0
    v_and_b32 v54, s35, v81
    v_and_b32 v55, s35, v89
    v_mfma_f32_16x16x32_bf16 v[128:131], v[104:107], a[72:75], v[128:131]
    buffer_load_dwordx4 v6, s[8:11], s20 offen lds
    v_mfma_f32_16x16x32_bf16 v[136:139], v[104:107], a[76:79], v[136:139]
    v_add_f32 v52, v52, v53
    v_add_f32 v54, v54, v55
    v_mfma_f32_16x16x32_bf16 v[136:139], v[88:91], a[72:75], v[136:139]
    v_cvt_pk_bf16_f32 v113, v52, v54
    v_lshlrev_b32 v52, 16, v82
    v_mfma_f32_16x16x32_bf16 v[136:139], a[180:183], a[68:71], v[136:139]
    v_lshlrev_b32 v53, 16, v90
    v_and_b32 v54, s35, v82
    v_mfma_f32_16x16x32_bf16 v[144:147], a[180:183], a[72:75], v[144:147]
    v_and_b32 v55, s35, v90
    v_add_f32 v52, v52, v53
    v_mfma_f32_16x16x32_bf16 v[144:147], v[88:91], a[76:79], v[144:147]
    v_add_f32 v54, v54, v55
    v_cvt_pk_bf16_f32 v114, v52, v54
    v_mfma_f32_16x16x32_bf16 v[144:147], v[104:107], a[80:83], v[144:147]
    buffer_load_dwordx4 v6, s[8:11], s21 offen offset:1024 lds
    v_mfma_f32_16x16x32_bf16 v[152:155], v[104:107], a[84:87], v[152:155]
    v_lshlrev_b32 v52, 16, v83
    v_lshlrev_b32 v53, 16, v91
    v_mfma_f32_16x16x32_bf16 v[152:155], v[88:91], a[80:83], v[152:155]
    v_and_b32 v54, s35, v83
    v_and_b32 v55, s35, v91
    v_mfma_f32_16x16x32_bf16 v[152:155], a[180:183], a[76:79], v[152:155]
    v_add_f32 v52, v52, v53
    v_add_f32 v54, v54, v55
    v_mfma_f32_16x16x32_bf16 v[160:163], a[180:183], a[80:83], v[160:163]
    v_cvt_pk_bf16_f32 v115, v52, v54
    v_lshlrev_b32 v52, 16, v96
    v_mfma_f32_16x16x32_bf16 v[160:163], v[88:91], a[84:87], v[160:163]
    v_lshlrev_b32 v53, 16, v104
    v_and_b32 v54, s35, v96
    v_mfma_f32_16x16x32_bf16 v[160:163], v[104:107], a[88:91], v[160:163]
    buffer_load_dwordx4 v6, s[8:11], s22 offen offset:2048 lds
    v_mfma_f32_16x16x32_bf16 v[168:171], v[104:107], a[92:95], v[168:171]
    v_and_b32 v55, s35, v104
    v_add_f32 v52, v52, v53
    v_mfma_f32_16x16x32_bf16 v[168:171], v[88:91], a[88:91], v[168:171]
    v_add_f32 v54, v54, v55
    v_cvt_pk_bf16_f32 v120, v52, v54
    v_mfma_f32_16x16x32_bf16 v[168:171], a[180:183], a[84:87], v[168:171]
    v_lshlrev_b32 v52, 16, v97
    v_lshlrev_b32 v53, 16, v105
    v_mfma_f32_16x16x32_bf16 v[176:179], a[180:183], a[88:91], v[176:179]
    v_and_b32 v54, s35, v97
    v_and_b32 v55, s35, v105
    v_mfma_f32_16x16x32_bf16 v[176:179], v[88:91], a[92:95], v[176:179]
    v_add_f32 v52, v52, v53
    v_add_f32 v54, v54, v55
    v_mfma_f32_16x16x32_bf16 v[176:179], v[104:107], a[96:99], v[176:179]
    buffer_load_dwordx4 v6, s[8:11], s23 offen offset:3072 lds
    v_mfma_f32_16x16x32_bf16 v[184:187], v[104:107], a[100:103], v[184:187]
    v_cvt_pk_bf16_f32 v121, v52, v54
    v_lshlrev_b32 v52, 16, v98
    v_mfma_f32_16x16x32_bf16 v[184:187], v[88:91], a[96:99], v[184:187]
    v_lshlrev_b32 v53, 16, v106
    v_and_b32 v54, s35, v98
    v_mfma_f32_16x16x32_bf16 v[184:187], a[180:183], a[92:95], v[184:187]
    v_and_b32 v55, s35, v106
    v_add_f32 v52, v52, v53
    v_mfma_f32_16x16x32_bf16 v[132:135], a[184:187], a[64:67], v[132:135]
    v_add_f32 v54, v54, v55
    v_cvt_pk_bf16_f32 v122, v52, v54
    v_mfma_f32_16x16x32_bf16 v[132:135], v[92:95], a[68:71], v[132:135]
    s_add_u32 m0, s31, 4096
    v_lshlrev_b32 v52, 16, v99
    v_lshlrev_b32 v53, 16, v107
    v_mfma_f32_16x16x32_bf16 v[132:135], v[108:111], a[72:75], v[132:135]
    buffer_load_dwordx4 v6, s[8:11], s24 offen lds
    v_mfma_f32_16x16x32_bf16 v[140:143], v[108:111], a[76:79], v[140:143]
    v_and_b32 v54, s35, v99
    v_and_b32 v55, s35, v107
    v_mfma_f32_16x16x32_bf16 v[140:143], v[92:95], a[72:75], v[140:143]
    v_add_f32 v52, v52, v53
    v_add_f32 v54, v54, v55
    v_mfma_f32_16x16x32_bf16 v[140:143], a[184:187], a[68:71], v[140:143]
    v_cvt_pk_bf16_f32 v123, v52, v54
    v_lshlrev_b32 v52, 16, v84
    v_mfma_f32_16x16x32_bf16 v[148:151], a[184:187], a[72:75], v[148:151]
    v_lshlrev_b32 v53, 16, v92
    v_and_b32 v54, s35, v84
    v_mfma_f32_16x16x32_bf16 v[148:151], v[92:95], a[76:79], v[148:151]
    v_and_b32 v55, s35, v92
    v_add_f32 v52, v52, v53
    v_mfma_f32_16x16x32_bf16 v[148:151], v[108:111], a[80:83], v[148:151]
    buffer_load_dwordx4 v6, s[8:11], s25 offen offset:1024 lds
    v_mfma_f32_16x16x32_bf16 v[156:159], v[108:111], a[84:87], v[156:159]
    v_add_f32 v54, v54, v55
    v_cvt_pk_bf16_f32 v116, v52, v54
    v_mfma_f32_16x16x32_bf16 v[156:159], v[92:95], a[80:83], v[156:159]
    v_lshlrev_b32 v52, 16, v85
    v_lshlrev_b32 v53, 16, v93
    v_mfma_f32_16x16x32_bf16 v[156:159], a[184:187], a[76:79], v[156:159]
    v_and_b32 v54, s35, v85
    v_and_b32 v55, s35, v93
    v_mfma_f32_16x16x32_bf16 v[164:167], a[184:187], a[80:83], v[164:167]
    v_add_f32 v52, v52, v53
    v_add_f32 v54, v54, v55
    v_mfma_f32_16x16x32_bf16 v[164:167], v[92:95], a[84:87], v[164:167]
    v_cvt_pk_bf16_f32 v117, v52, v54
    v_lshlrev_b32 v52, 16, v86
    v_mfma_f32_16x16x32_bf16 v[164:167], v[108:111], a[88:91], v[164:167]
    buffer_load_dwordx4 v6, s[8:11], s26 offen offset:2048 lds
    v_mfma_f32_16x16x32_bf16 v[172:175], v[108:111], a[92:95], v[172:175]
    v_lshlrev_b32 v53, 16, v94
    v_and_b32 v54, s35, v86
    v_mfma_f32_16x16x32_bf16 v[172:175], v[92:95], a[88:91], v[172:175]
    v_and_b32 v55, s35, v94
    v_add_f32 v52, v52, v53
    v_mfma_f32_16x16x32_bf16 v[172:175], a[184:187], a[84:87], v[172:175]
    v_add_f32 v54, v54, v55
    v_cvt_pk_bf16_f32 v118, v52, v54
    v_mfma_f32_16x16x32_bf16 v[180:183], a[184:187], a[88:91], v[180:183]
    v_lshlrev_b32 v52, 16, v87
    v_lshlrev_b32 v53, 16, v95
    v_mfma_f32_16x16x32_bf16 v[180:183], v[92:95], a[92:95], v[180:183]
    v_and_b32 v54, s35, v87
    v_and_b32 v55, s35, v95
    v_mfma_f32_16x16x32_bf16 v[180:183], v[108:111], a[96:99], v[180:183]
    buffer_load_dwordx4 v6, s[8:11], s27 offen offset:3072 lds
    v_mfma_f32_16x16x32_bf16 v[188:191], v[108:111], a[100:103], v[188:191]
    v_add_f32 v52, v52, v53
    v_add_f32 v54, v54, v55
    v_mfma_f32_16x16x32_bf16 v[188:191], v[92:95], a[96:99], v[188:191]
    v_cvt_pk_bf16_f32 v119, v52, v54
    v_lshlrev_b32 v52, 16, v100
    v_mfma_f32_16x16x32_bf16 v[188:191], a[184:187], a[92:95], v[188:191]
    v_lshlrev_b32 v53, 16, v108
    v_and_b32 v54, s35, v100
    v_mfma_f32_16x16x32_bf16 v[192:195], v[80:83], a[104:107], v[192:195]
    v_and_b32 v55, s35, v108
    v_add_f32 v52, v52, v53
    v_mfma_f32_16x16x32_bf16 v[192:195], v[96:99], a[108:111], v[192:195]
    s_add_u32 m0, s31, 8192
    v_add_f32 v54, v54, v55
    v_cvt_pk_bf16_f32 v124, v52, v54
    v_mfma_f32_16x16x32_bf16 v[200:203], v[96:99], a[112:115], v[200:203]
    buffer_load_dwordx4 v6, s[8:11], s28 offen lds
    v_mfma_f32_16x16x32_bf16 v[200:203], v[80:83], a[108:111], v[200:203]
    v_lshlrev_b32 v52, 16, v101
    v_lshlrev_b32 v53, 16, v109
    v_mfma_f32_16x16x32_bf16 v[208:211], v[80:83], a[112:115], v[208:211]
    v_and_b32 v54, s35, v101
    v_and_b32 v55, s35, v109
    v_mfma_f32_16x16x32_bf16 v[208:211], v[96:99], a[116:119], v[208:211]
    v_add_f32 v52, v52, v53
    v_add_f32 v54, v54, v55
    v_mfma_f32_16x16x32_bf16 v[216:219], v[96:99], a[120:123], v[216:219]
    v_cvt_pk_bf16_f32 v125, v52, v54
    v_lshlrev_b32 v52, 16, v102
    v_mfma_f32_16x16x32_bf16 v[216:219], v[80:83], a[116:119], v[216:219]
    v_lshlrev_b32 v53, 16, v110
    v_and_b32 v54, s35, v102
    v_mfma_f32_16x16x32_bf16 v[224:227], v[80:83], a[120:123], v[224:227]
    buffer_load_dwordx4 v6, s[8:11], s29 offen offset:1024 lds
    v_mfma_f32_16x16x32_bf16 v[224:227], v[96:99], a[124:127], v[224:227]
    s_add_u32 s8, s8, 0x10000
    s_addc_u32 s9, s9, 0
    v_and_b32 v55, s35, v110
    v_mfma_f32_16x16x32_bf16 v[232:235], v[96:99], a[128:131], v[232:235]
    s_sub_u32 s10, s10, 0x10000
    v_add_f32 v52, v52, v53
    v_add_f32 v54, v54, v55
    v_mfma_f32_16x16x32_bf16 v[232:235], v[80:83], a[124:127], v[232:235]
    s_waitcnt vmcnt(11) lgkmcnt(0)
    s_barrier
    v_cvt_pk_bf16_f32 v126, v52, v54
    v_mfma_f32_16x16x32_bf16 v[240:243], v[80:83], a[128:131], v[240:243]
    s_add_u32 m0, s30, 49152
    ds_read_b128 v[24:27], v5 offset:0
    v_lshlrev_b32 v52, 16, v103
    v_mfma_f32_16x16x32_bf16 v[240:243], v[96:99], a[132:135], v[240:243]
    buffer_load_dwordx4 v68, s[4:7], s17 offen lds
    v_mfma_f32_16x16x32_bf16 v[248:251], v[96:99], a[136:139], v[248:251]
    ds_read_b128 v[28:31], v5 offset:1024
    v_lshlrev_b32 v53, 16, v111
    v_mfma_f32_16x16x32_bf16 v[248:251], v[80:83], a[132:135], v[248:251]
    ds_read_b128 v[32:35], v5 offset:2048
    v_and_b32 v54, s35, v103
    v_mfma_f32_16x16x32_bf16 v[196:199], v[84:87], a[104:107], v[196:199]
    ds_read_b128 v[36:39], v5 offset:3072
    v_and_b32 v55, s35, v111
    v_mfma_f32_16x16x32_bf16 v[196:199], v[100:103], a[108:111], v[196:199]
    ds_read_b128 a[140:143], v7 offset:6128
    v_add_f32 v52, v52, v53
    v_mfma_f32_16x16x32_bf16 v[204:207], v[100:103], a[112:115], v[204:207]
    ds_read_b128 a[144:147], v7 offset:7152
    v_add_f32 v54, v54, v55
    v_mfma_f32_16x16x32_bf16 v[204:207], v[84:87], a[108:111], v[204:207]
    buffer_load_dwordx4 v69, s[4:7], s17 offen offset:1024 lds
    v_mfma_f32_16x16x32_bf16 v[212:215], v[84:87], a[112:115], v[212:215]
    ds_read_b128 a[148:151], v7 offset:0
    v_cvt_pk_bf16_f32 v127, v52, v54
    v_mfma_f32_16x16x32_bf16 v[212:215], v[100:103], a[116:119], v[212:215]
    ds_read_b128 a[152:155], v7 offset:1024
    v_mfma_f32_16x16x32_bf16 v[220:223], v[100:103], a[120:123], v[220:223]
    s_waitcnt lgkmcnt(7)
    ds_read_b128 a[156:159], v7 offset:2048
    v_lshlrev_b32 v48, 16, v24
    v_mfma_f32_16x16x32_bf16 v[220:223], v[84:87], a[116:119], v[220:223]
    s_waitcnt lgkmcnt(7)
    ds_read_b128 a[160:163], v7 offset:3072
    v_lshlrev_b32 v49, 16, v28
    v_mfma_f32_16x16x32_bf16 v[228:231], v[84:87], a[120:123], v[228:231]
    ds_read_b128 a[164:167], v7 offset:4096
    v_and_b32 v50, s35, v24
    v_mfma_f32_16x16x32_bf16 v[228:231], v[100:103], a[124:127], v[228:231]
    buffer_load_dwordx4 v70, s[4:7], s17 offen offset:2048 lds
    v_mfma_f32_16x16x32_bf16 v[236:239], v[100:103], a[128:131], v[236:239]
    ds_read_b128 a[168:171], v7 offset:5120
    v_and_b32 v51, s35, v28
    v_mfma_f32_16x16x32_bf16 v[236:239], v[84:87], a[124:127], v[236:239]
    ds_read_b128 a[172:175], v7 offset:6144
    v_add_f32 v48, v48, v49
    v_mfma_f32_16x16x32_bf16 v[244:247], v[84:87], a[128:131], v[244:247]
    ds_read_b128 a[176:179], v7 offset:7168
    v_add_f32 v50, v50, v51
    v_mfma_f32_16x16x32_bf16 v[244:247], v[100:103], a[132:135], v[244:247]
    ds_read_b128 a[64:67], v3 offset:12288
    v_cvt_pk_bf16_f32 v40, v48, v50
    v_mfma_f32_16x16x32_bf16 v[252:255], v[100:103], a[136:139], v[252:255]
    ds_read_b128 a[68:71], v3 offset:14336
    v_lshlrev_b32 v48, 16, v25
    v_mfma_f32_16x16x32_bf16 v[252:255], v[84:87], a[132:135], v[252:255]
    s_waitcnt lgkmcnt(11)
    buffer_load_dwordx4 v71, s[4:7], s17 offen offset:3072 lds
    v_mfma_f32_16x16x32_bf16 a[0:3], a[180:183], a[140:143], a[0:3]
    s_waitcnt lgkmcnt(10)
    s_add_u32 s17, s17, 128
    ds_read_b128 a[72:75], v9 offset:0
    v_lshlrev_b32 v49, 16, v29
    v_mfma_f32_16x16x32_bf16 a[0:3], v[112:115], a[144:147], a[0:3]
    s_waitcnt lgkmcnt(10)
    ds_read_b128 a[76:79], v9 offset:2048
    v_and_b32 v50, s35, v25
    v_mfma_f32_16x16x32_bf16 a[0:3], v[120:123], a[148:151], a[0:3]
    s_waitcnt lgkmcnt(10)
    buffer_load_dword v23, v14, s[64:67], s68 offen
    v_mfma_f32_16x16x32_bf16 a[8:11], v[120:123], a[152:155], a[8:11]
    s_add_u32 s68, s68, s70
    ds_read_b128 a[80:83], v9 offset:4096
    v_and_b32 v51, s35, v29
    v_mfma_f32_16x16x32_bf16 a[8:11], v[112:115], a[148:151], a[8:11]
    s_min_u32 s68, s68, s71
    ds_read_b128 a[84:87], v9 offset:6144
    v_add_f32 v48, v48, v49
    v_mfma_f32_16x16x32_bf16 a[8:11], a[180:183], a[144:147], a[8:11]
    ds_read_b128 a[88:91], v9 offset:8192
    v_add_f32 v50, v50, v51
    v_mfma_f32_16x16x32_bf16 a[16:19], a[180:183], a[148:151], a[16:19]
    ds_read_b128 a[92:95], v9 offset:10240
    v_cvt_pk_bf16_f32 v41, v48, v50
    v_mfma_f32_16x16x32_bf16 a[16:19], v[112:115], a[152:155], a[16:19]
    s_waitcnt lgkmcnt(13)
    ds_read_b128 a[96:99], v9 offset:12288
    v_lshlrev_b32 v48, 16, v26
    v_mfma_f32_16x16x32_bf16 a[16:19], v[120:123], a[156:159], a[16:19]
    s_waitcnt lgkmcnt(13)
    ds_read_b128 a[100:103], v9 offset:14336
    v_lshlrev_b32 v49, 16, v30
    v_mfma_f32_16x16x32_bf16 a[24:27], v[120:123], a[160:163], a[24:27]
    ds_read_b64_tr_b16 a[188:189], v12 offset:40960
    v_and_b32 v50, s35, v26
    v_mfma_f32_16x16x32_bf16 a[24:27], v[112:115], a[156:159], a[24:27]
    ds_read_b64_tr_b16 a[190:191], v12 offset:41984
    v_and_b32 v51, s35, v30
    v_mfma_f32_16x16x32_bf16 a[24:27], a[180:183], a[152:155], a[24:27]
    ds_read_b64_tr_b16 a[192:193], v13 offset:40960
    v_add_f32 v48, v48, v49
    v_mfma_f32_16x16x32_bf16 a[32:35], a[180:183], a[156:159], a[32:35]
    ds_read_b64_tr_b16 a[194:195], v13 offset:41984
    v_add_f32 v50, v50, v51
    v_mfma_f32_16x16x32_bf16 a[32:35], v[112:115], a[160:163], a[32:35]
    s_waitcnt lgkmcnt(15)
    ds_read_b64_tr_b16 v[88:89], v12 offset:45056
    v_cvt_pk_bf16_f32 v42, v48, v50
    v_mfma_f32_16x16x32_bf16 a[32:35], v[120:123], a[164:167], a[32:35]
    ds_read_b64_tr_b16 v[90:91], v12 offset:46080
    v_lshlrev_b32 v48, 16, v27
    v_mfma_f32_16x16x32_bf16 a[40:43], v[120:123], a[168:171], a[40:43]
    ds_read_b64_tr_b16 v[104:105], v12 offset:49152
    v_lshlrev_b32 v49, 16, v31
    v_mfma_f32_16x16x32_bf16 a[40:43], v[112:115], a[164:167], a[40:43]
    ds_read_b64_tr_b16 v[106:107], v12 offset:50176
    v_and_b32 v50, s35, v27
    v_mfma_f32_16x16x32_bf16 a[40:43], a[180:183], a[160:163], a[40:43]
    ds_read_b64_tr_b16 v[92:93], v13 offset:45056
    v_and_b32 v51, s35, v31
    v_mfma_f32_16x16x32_bf16 a[48:51], a[180:183], a[164:167], a[48:51]
    ds_read_b64_tr_b16 v[94:95], v13 offset:46080
    v_add_f32 v48, v48, v49
    v_mfma_f32_16x16x32_bf16 a[48:51], v[112:115], a[168:171], a[48:51]
    ds_read_b64_tr_b16 v[108:109], v13 offset:49152
    v_add_f32 v50, v50, v51
    v_mfma_f32_16x16x32_bf16 a[48:51], v[120:123], a[172:175], a[48:51]
    s_waitcnt lgkmcnt(15)
    ds_read_b64_tr_b16 v[110:111], v13 offset:50176
    v_cvt_pk_bf16_f32 v43, v48, v50
    v_lshlrev_b32 v48, 16, v32
    v_mfma_f32_16x16x32_bf16 a[56:59], v[120:123], a[176:179], a[56:59]
    ds_read_b128 a[104:107], v3 offset:15360
    v_lshlrev_b32 v49, 16, v36
    v_mfma_f32_16x16x32_bf16 a[56:59], v[112:115], a[172:175], a[56:59]
    ds_write_b128 v11, v[40:43] offset:8192
    v_and_b32 v50, s35, v32
    v_mfma_f32_16x16x32_bf16 a[56:59], a[180:183], a[168:171], a[56:59]
    ds_read_b128 a[108:111], v9 offset:1024
    v_and_b32 v51, s35, v36
    v_mfma_f32_16x16x32_bf16 a[4:7], a[184:187], a[140:143], a[4:7]
    ds_read_b128 a[112:115], v9 offset:3072
    v_add_f32 v48, v48, v49
    v_mfma_f32_16x16x32_bf16 a[4:7], v[116:119], a[144:147], a[4:7]
    ds_read_b128 a[116:119], v9 offset:5120
    v_add_f32 v50, v50, v51
    v_mfma_f32_16x16x32_bf16 a[4:7], v[124:127], a[148:151], a[4:7]
    ds_read_b128 a[120:123], v9 offset:7168
    v_cvt_pk_bf16_f32 v44, v48, v50
    v_mfma_f32_16x16x32_bf16 a[12:15], v[124:127], a[152:155], a[12:15]
    ds_read_b128 a[124:127], v9 offset:9216
    v_lshlrev_b32 v48, 16, v33
    v_mfma_f32_16x16x32_bf16 a[12:15], v[116:119], a[148:151], a[12:15]
    ds_read_b128 a[128:131], v9 offset:11264
    v_lshlrev_b32 v49, 16, v37
    v_mfma_f32_16x16x32_bf16 a[12:15], a[184:187], a[144:147], a[12:15]
    ds_read_b64_tr_b16 v[80:81], v12 offset:43008
    v_and_b32 v50, s35, v33
    v_mfma_f32_16x16x32_bf16 a[20:23], a[184:187], a[148:151], a[20:23]
    ds_read_b64_tr_b16 v[82:83], v12 offset:44032
    v_and_b32 v51, s35, v37
    v_mfma_f32_16x16x32_bf16 a[20:23], v[116:119], a[152:155], a[20:23]
    ds_read_b64_tr_b16 v[96:97], v12 offset:47104
    v_add_f32 v48, v48, v49
    v_add_f32 v50, v50, v51
    v_mfma_f32_16x16x32_bf16 a[20:23], v[124:127], a[156:159], a[20:23]
    ds_read_b64_tr_b16 v[98:99], v12 offset:48128
    v_cvt_pk_bf16_f32 v45, v48, v50
    v_mfma_f32_16x16x32_bf16 a[28:31], v[124:127], a[160:163], a[28:31]
    ds_read_b64_tr_b16 v[84:85], v13 offset:43008
    v_lshlrev_b32 v48, 16, v34
    v_mfma_f32_16x16x32_bf16 a[28:31], v[116:119], a[156:159], a[28:31]
    ds_read_b64_tr_b16 v[86:87], v13 offset:44032
    v_lshlrev_b32 v49, 16, v38
    v_mfma_f32_16x16x32_bf16 a[28:31], a[184:187], a[152:155], a[28:31]
    ds_read_b64_tr_b16 v[100:101], v13 offset:47104
    v_and_b32 v50, s35, v34
    v_mfma_f32_16x16x32_bf16 a[36:39], a[184:187], a[156:159], a[36:39]
    ds_read_b64_tr_b16 v[102:103], v13 offset:48128
    v_and_b32 v51, s35, v38
    v_mfma_f32_16x16x32_bf16 a[36:39], v[116:119], a[160:163], a[36:39]
    ds_read_b128 a[132:135], v9 offset:13312
    v_add_f32 v48, v48, v49
    v_mfma_f32_16x16x32_bf16 a[36:39], v[124:127], a[164:167], a[36:39]
    ds_read_b128 a[136:139], v9 offset:15360
    v_add_f32 v50, v50, v51
    v_mfma_f32_16x16x32_bf16 a[44:47], v[124:127], a[168:171], a[44:47]
    v_cvt_pk_bf16_f32 v46, v48, v50
    v_lshlrev_b32 v48, 16, v35
    v_mfma_f32_16x16x32_bf16 a[44:47], v[116:119], a[164:167], a[44:47]
    v_lshlrev_b32 v49, 16, v39
    v_and_b32 v50, s35, v35
    v_mfma_f32_16x16x32_bf16 a[44:47], a[184:187], a[160:163], a[44:47]
    v_and_b32 v51, s35, v39
    v_add_f32 v48, v48, v49
    v_mfma_f32_16x16x32_bf16 a[52:55], a[184:187], a[164:167], a[52:55]
    v_add_f32 v50, v50, v51
    v_cvt_pk_bf16_f32 v47, v48, v50
    v_mfma_f32_16x16x32_bf16 a[52:55], v[116:119], a[168:171], a[52:55]
    ds_write_b128 v11, v[44:47] offset:9216
    v_mfma_f32_16x16x32_bf16 a[52:55], v[124:127], a[172:175], a[52:55]
    s_waitcnt lgkmcnt(10)
    v_lshlrev_b32 v52, 16, v80
    v_lshlrev_b32 v53, 16, v88
    v_mfma_f32_16x16x32_bf16 a[60:63], v[124:127], a[176:179], a[60:63]
    v_and_b32 v54, s35, v80
    v_and_b32 v55, s35, v88
    v_mfma_f32_16x16x32_bf16 a[60:63], v[116:119], a[172:175], a[60:63]
    v_add_f32 v52, v52, v53
    v_add_f32 v54, v54, v55
    v_mfma_f32_16x16x32_bf16 a[60:63], a[184:187], a[168:171], a[60:63]
    s_waitcnt lgkmcnt(1)
    v_cvt_pk_bf16_f32 v112, v52, v54
    s_add_u32 s19, s19, 4
    s_cmp_lt_u32 s19, 12
    s_cbranch_scc1 L_loop
    v_mfma_f32_16x16x32_bf16 v[128:131], a[188:191], a[64:67], v[128:131]
    s_barrier
    v_lshlrev_b32 v52, 16, v81
    v_lshlrev_b32 v53, 16, v89
    v_mfma_f32_16x16x32_bf16 v[128:131], v[88:91], a[68:71], v[128:131]
    s_add_u32 m0, s31, 40960
    v_and_b32 v54, s35, v81
    v_and_b32 v55, s35, v89
    v_mfma_f32_16x16x32_bf16 v[128:131], v[104:107], a[72:75], v[128:131]
    buffer_load_dwordx4 v6, s[8:11], s20 offen lds
    v_mfma_f32_16x16x32_bf16 v[136:139], v[104:107], a[76:79], v[136:139]
    v_add_f32 v52, v52, v53
    v_add_f32 v54, v54, v55
    v_mfma_f32_16x16x32_bf16 v[136:139], v[88:91], a[72:75], v[136:139]
    v_cvt_pk_bf16_f32 v113, v52, v54
    v_lshlrev_b32 v52, 16, v82
    v_mfma_f32_16x16x32_bf16 v[136:139], a[188:191], a[68:71], v[136:139]
    buffer_load_dwordx4 v6, s[8:11], s21 offen offset:1024 lds
    v_mfma_f32_16x16x32_bf16 v[144:147], a[188:191], a[72:75], v[144:147]
    v_lshlrev_b32 v53, 16, v90
    v_and_b32 v54, s35, v82
    v_mfma_f32_16x16x32_bf16 v[144:147], v[88:91], a[76:79], v[144:147]
    v_and_b32 v55, s35, v90
    v_add_f32 v52, v52, v53
    v_mfma_f32_16x16x32_bf16 v[144:147], v[104:107], a[80:83], v[144:147]
    buffer_load_dwordx4 v6, s[8:11], s22 offen offset:2048 lds
    v_mfma_f32_16x16x32_bf16 v[152:155], v[104:107], a[84:87], v[152:155]
    v_add_f32 v54, v54, v55
    v_cvt_pk_bf16_f32 v114, v52, v54
    v_mfma_f32_16x16x32_bf16 v[152:155], v[88:91], a[80:83], v[152:155]
    v_lshlrev_b32 v52, 16, v83
    v_lshlrev_b32 v53, 16, v91
    v_mfma_f32_16x16x32_bf16 v[152:155], a[188:191], a[76:79], v[152:155]
    buffer_load_dwordx4 v6, s[8:11], s23 offen offset:3072 lds
    v_mfma_f32_16x16x32_bf16 v[160:163], a[188:191], a[80:83], v[160:163]
    v_and_b32 v54, s35, v83
    v_and_b32 v55, s35, v91
    v_mfma_f32_16x16x32_bf16 v[160:163], v[88:91], a[84:87], v[160:163]
    s_add_u32 m0, s31, 45056
    v_add_f32 v52, v52, v53
    v_add_f32 v54, v54, v55
    v_mfma_f32_16x16x32_bf16 v[160:163], v[104:107], a[88:91], v[160:163]
    buffer_load_dwordx4 v6, s[8:11], s24 offen lds
    v_mfma_f32_16x16x32_bf16 v[168:171], v[104:107], a[92:95], v[168:171]
    v_cvt_pk_bf16_f32 v115, v52, v54
    v_lshlrev_b32 v52, 16, v96
    v_mfma_f32_16x16x32_bf16 v[168:171], v[88:91], a[88:91], v[168:171]
    v_lshlrev_b32 v53, 16, v104
    v_and_b32 v54, s35, v96
    v_mfma_f32_16x16x32_bf16 v[168:171], a[188:191], a[84:87], v[168:171]
    buffer_load_dwordx4 v6, s[8:11], s25 offen offset:1024 lds
    v_mfma_f32_16x16x32_bf16 v[176:179], a[188:191], a[88:91], v[176:179]
    v_and_b32 v55, s35, v104
    v_add_f32 v52, v52, v53
    v_mfma_f32_16x16x32_bf16 v[176:179], v[88:91], a[92:95], v[176:179]
    v_add_f32 v54, v54, v55
    v_cvt_pk_bf16_f32 v120, v52, v54
    v_mfma_f32_16x16x32_bf16 v[176:179], v[104:107], a[96:99], v[176:179]
    buffer_load_dwordx4 v6, s[8:11], s26 offen offset:2048 lds
    v_mfma_f32_16x16x32_bf16 v[184:187], v[104:107], a[100:103], v[184:187]
    v_lshlrev_b32 v52, 16, v97
    v_lshlrev_b32 v53, 16, v105
    v_mfma_f32_16x16x32_bf16 v[184:187], v[88:91], a[96:99], v[184:187]
    v_and_b32 v54, s35, v97
    v_and_b32 v55, s35, v105
    v_mfma_f32_16x16x32_bf16 v[184:187], a[188:191], a[92:95], v[184:187]
    buffer_load_dwordx4 v6, s[8:11], s27 offen offset:3072 lds
    v_mfma_f32_16x16x32_bf16 v[132:135], a[192:195], a[64:67], v[132:135]
    v_add_f32 v52, v52, v53
    v_add_f32 v54, v54, v55
    v_mfma_f32_16x16x32_bf16 v[132:135], v[92:95], a[68:71], v[132:135]
    s_add_u32 m0, s31, 49152
    v_cvt_pk_bf16_f32 v121, v52, v54
    v_lshlrev_b32 v52, 16, v98
    v_mfma_f32_16x16x32_bf16 v[132:135], v[108:111], a[72:75], v[132:135]
    buffer_load_dwordx4 v6, s[8:11], s28 offen lds
    v_mfma_f32_16x16x32_bf16 v[140:143], v[108:111], a[76:79], v[140:143]
    v_lshlrev_b32 v53, 16, v106
    v_and_b32 v54, s35, v98
    v_mfma_f32_16x16x32_bf16 v[140:143], v[92:95], a[72:75], v[140:143]
    v_and_b32 v55, s35, v106
    v_add_f32 v52, v52, v53
    v_mfma_f32_16x16x32_bf16 v[140:143], a[192:195], a[68:71], v[140:143]
    buffer_load_dwordx4 v6, s[8:11], s29 offen offset:1024 lds
    v_mfma_f32_16x16x32_bf16 v[148:151], a[192:195], a[72:75], v[148:151]
    v_add_f32 v54, v54, v55
    v_cvt_pk_bf16_f32 v122, v52, v54
    v_mfma_f32_16x16x32_bf16 v[148:151], v[92:95], a[76:79], v[148:151]
    v_lshlrev_b32 v52, 16, v99
    v_lshlrev_b32 v53, 16, v107
    v_mfma_f32_16x16x32_bf16 v[148:151], v[108:111], a[80:83], v[148:151]
    v_and_b32 v54, s35, v99
    v_and_b32 v55, s35, v107
    v_mfma_f32_16x16x32_bf16 v[156:159], v[108:111], a[84:87], v[156:159]
    v_add_f32 v52, v52, v53
    v_add_f32 v54, v54, v55
    v_mfma_f32_16x16x32_bf16 v[156:159], v[92:95], a[80:83], v[156:159]
    v_cvt_pk_bf16_f32 v123, v52, v54
    v_lshlrev_b32 v52, 16, v84
    v_mfma_f32_16x16x32_bf16 v[156:159], a[192:195], a[76:79], v[156:159]
    v_lshlrev_b32 v53, 16, v92
    v_and_b32 v54, s35, v84
    v_mfma_f32_16x16x32_bf16 v[164:167], a[192:195], a[80:83], v[164:167]
    v_and_b32 v55, s35, v92
    v_add_f32 v52, v52, v53
    v_mfma_f32_16x16x32_bf16 v[164:167], v[92:95], a[84:87], v[164:167]
    v_add_f32 v54, v54, v55
    v_cvt_pk_bf16_f32 v116, v52, v54
    v_mfma_f32_16x16x32_bf16 v[164:167], v[108:111], a[88:91], v[164:167]
    v_lshlrev_b32 v52, 16, v85
    v_lshlrev_b32 v53, 16, v93
    v_mfma_f32_16x16x32_bf16 v[172:175], v[108:111], a[92:95], v[172:175]
    v_and_b32 v54, s35, v85
    v_and_b32 v55, s35, v93
    v_mfma_f32_16x16x32_bf16 v[172:175], v[92:95], a[88:91], v[172:175]
    v_add_f32 v52, v52, v53
    v_add_f32 v54, v54, v55
    v_mfma_f32_16x16x32_bf16 v[172:175], a[192:195], a[84:87], v[172:175]
    v_cvt_pk_bf16_f32 v117, v52, v54
    v_lshlrev_b32 v52, 16, v86
    v_mfma_f32_16x16x32_bf16 v[180:183], a[192:195], a[88:91], v[180:183]
    v_lshlrev_b32 v53, 16, v94
    v_and_b32 v54, s35, v86
    v_mfma_f32_16x16x32_bf16 v[180:183], v[92:95], a[92:95], v[180:183]
    v_and_b32 v55, s35, v94
    v_add_f32 v52, v52, v53
    v_mfma_f32_16x16x32_bf16 v[180:183], v[108:111], a[96:99], v[180:183]
    v_add_f32 v54, v54, v55
    v_cvt_pk_bf16_f32 v118, v52, v54
    v_mfma_f32_16x16x32_bf16 v[188:191], v[108:111], a[100:103], v[188:191]
    v_lshlrev_b32 v52, 16, v87
    v_lshlrev_b32 v53, 16, v95
    v_mfma_f32_16x16x32_bf16 v[188:191], v[92:95], a[96:99], v[188:191]
    v_and_b32 v54, s35, v87
    v_and_b32 v55, s35, v95
    v_mfma_f32_16x16x32_bf16 v[188:191], a[192:195], a[92:95], v[188:191]
    v_add_f32 v52, v52, v53
    v_add_f32 v54, v54, v55
    v_mfma_f32_16x16x32_bf16 v[192:195], v[80:83], a[104:107], v[192:195]
    v_cvt_pk_bf16_f32 v119, v52, v54
    v_lshlrev_b32 v52, 16, v100
    v_mfma_f32_16x16x32_bf16 v[192:195], v[96:99], a[108:111], v[192:195]
    v_lshlrev_b32 v53, 16, v108
    v_and_b32 v54, s35, v100
    v_mfma_f32_16x16x32_bf16 v[200:203], v[96:99], a[112:115], v[200:203]
    v_and_b32 v55, s35, v108
    v_add_f32 v52, v52, v53
    v_mfma_f32_16x16x32_bf16 v[200:203], v[80:83], a[108:111], v[200:203]
    v_add_f32 v54, v54, v55
    v_cvt_pk_bf16_f32 v124, v52, v54
    v_mfma_f32_16x16x32_bf16 v[208:211], v[80:83], a[112:115], v[208:211]
    v_lshlrev_b32 v52, 16, v101
    v_lshlrev_b32 v53, 16, v109
    v_mfma_f32_16x16x32_bf16 v[208:211], v[96:99], a[116:119], v[208:211]
    v_and_b32 v54, s35, v101
    v_and_b32 v55, s35, v109
    v_mfma_f32_16x16x32_bf16 v[216:219], v[96:99], a[120:123], v[216:219]
    v_add_f32 v52, v52, v53
    v_add_f32 v54, v54, v55
    v_mfma_f32_16x16x32_bf16 v[216:219], v[80:83], a[116:119], v[216:219]
    s_waitcnt vmcnt(10) lgkmcnt(0)
    s_barrier
    v_cvt_pk_bf16_f32 v125, v52, v54
    v_mfma_f32_16x16x32_bf16 v[224:227], v[80:83], a[120:123], v[224:227]
    ds_read_b128 a[140:143], v7 offset:14320
    v_lshlrev_b32 v52, 16, v102
    v_mfma_f32_16x16x32_bf16 v[224:227], v[96:99], a[124:127], v[224:227]
    ds_read_b128 a[144:147], v7 offset:15344
    v_lshlrev_b32 v53, 16, v110
    v_mfma_f32_16x16x32_bf16 v[232:235], v[96:99], a[128:131], v[232:235]
    ds_read_b128 a[148:151], v7 offset:8192
    v_and_b32 v54, s35, v102
    v_mfma_f32_16x16x32_bf16 v[232:235], v[80:83], a[124:127], v[232:235]
    ds_read_b128 a[152:155], v7 offset:9216
    v_and_b32 v55, s35, v110
    v_mfma_f32_16x16x32_bf16 v[240:243], v[80:83], a[128:131], v[240:243]
    ds_read_b128 a[156:159], v7 offset:10240
    v_add_f32 v52, v52, v53
    v_mfma_f32_16x16x32_bf16 v[240:243], v[96:99], a[132:135], v[240:243]
    ds_read_b128 a[64:67], v2 offset:45056
    v_add_f32 v54, v54, v55
    v_mfma_f32_16x16x32_bf16 v[248:251], v[96:99], a[136:139], v[248:251]
    ds_read_b128 a[68:71], v2 offset:47104
    v_cvt_pk_bf16_f32 v126, v52, v54
    v_mfma_f32_16x16x32_bf16 v[248:251], v[80:83], a[132:135], v[248:251]
    ds_read_b128 a[72:75], v8 offset:32768
    v_lshlrev_b32 v52, 16, v103
    v_mfma_f32_16x16x32_bf16 v[196:199], v[84:87], a[104:107], v[196:199]
    ds_read_b128 a[76:79], v8 offset:34816
    v_lshlrev_b32 v53, 16, v111
    v_mfma_f32_16x16x32_bf16 v[196:199], v[100:103], a[108:111], v[196:199]
    ds_read_b128 a[80:83], v8 offset:36864
    v_and_b32 v54, s35, v103
    v_mfma_f32_16x16x32_bf16 v[204:207], v[100:103], a[112:115], v[204:207]
    ds_read_b128 a[84:87], v8 offset:38912
    v_and_b32 v55, s35, v111
    v_mfma_f32_16x16x32_bf16 v[204:207], v[84:87], a[108:111], v[204:207]
    ds_read_b128 a[88:91], v8 offset:40960
    v_add_f32 v52, v52, v53
    v_mfma_f32_16x16x32_bf16 v[212:215], v[84:87], a[112:115], v[212:215]
    ds_read_b128 a[92:95], v8 offset:43008
    v_add_f32 v54, v54, v55
    v_mfma_f32_16x16x32_bf16 v[212:215], v[100:103], a[116:119], v[212:215]
    ds_read_b128 a[96:99], v8 offset:45056
    v_cvt_pk_bf16_f32 v127, v52, v54
    v_mfma_f32_16x16x32_bf16 v[220:223], v[100:103], a[120:123], v[220:223]
    ds_read_b128 a[100:103], v8 offset:47104
    v_mfma_f32_16x16x32_bf16 v[220:223], v[84:87], a[116:119], v[220:223]
    ds_read_b64_tr_b16 a[180:181], v12 offset:0
    v_mfma_f32_16x16x32_bf16 v[228:231], v[84:87], a[120:123], v[228:231]
    ds_read_b64_tr_b16 a[182:183], v12 offset:1024
    v_mfma_f32_16x16x32_bf16 v[228:231], v[100:103], a[124:127], v[228:231]
    ds_read_b64_tr_b16 a[184:185], v13 offset:0
    v_mfma_f32_16x16x32_bf16 v[236:239], v[100:103], a[128:131], v[236:239]
    ds_read_b64_tr_b16 a[186:187], v13 offset:1024
    v_mfma_f32_16x16x32_bf16 v[236:239], v[84:87], a[124:127], v[236:239]
    v_mfma_f32_16x16x32_bf16 v[244:247], v[84:87], a[128:131], v[244:247]
    v_mfma_f32_16x16x32_bf16 v[244:247], v[100:103], a[132:135], v[244:247]
    v_mfma_f32_16x16x32_bf16 v[252:255], v[100:103], a[136:139], v[252:255]
    v_mfma_f32_16x16x32_bf16 v[252:255], v[84:87], a[132:135], v[252:255]
    s_waitcnt vmcnt(0)
    s_barrier
    s_waitcnt lgkmcnt(15)
    v_mfma_f32_16x16x32_bf16 a[0:3], a[188:191], a[140:143], a[0:3]
    ds_read_b128 a[160:163], v7 offset:11264
    v_mfma_f32_16x16x32_bf16 a[0:3], v[112:115], a[144:147], a[0:3]
    ds_read_b128 a[164:167], v7 offset:12288
    v_mfma_f32_16x16x32_bf16 a[0:3], v[120:123], a[148:151], a[0:3]
    ds_read_b64_tr_b16 v[88:89], v12 offset:4096
    v_mfma_f32_16x16x32_bf16 a[4:7], v[124:127], a[148:151], a[4:7]
    ds_read_b64_tr_b16 v[90:91], v12 offset:5120
    v_mfma_f32_16x16x32_bf16 a[4:7], v[116:119], a[144:147], a[4:7]
    ds_read_b64_tr_b16 v[104:105], v12 offset:8192
    v_mfma_f32_16x16x32_bf16 a[4:7], a[192:195], a[140:143], a[4:7]
    ds_read_b64_tr_b16 v[106:107], v12 offset:9216
    v_mfma_f32_16x16x32_bf16 a[12:15], a[192:195], a[144:147], a[12:15]
    ds_read_b64_tr_b16 v[80:81], v12 offset:2048
    v_mfma_f32_16x16x32_bf16 a[12:15], v[116:119], a[148:151], a[12:15]
    ds_read_b64_tr_b16 v[82:83], v12 offset:3072
    v_mov_b32_dpp v72, v248 row_shr:1 row_mask:0xf bank_mask:0xf
    v_mov_b32_dpp v73, v249 row_shr:1 row_mask:0xf bank_mask:0xf
    v_mov_b32_dpp v74, v250 row_shr:1 row_mask:0xf bank_mask:0xf
    v_mov_b32_dpp v75, v251 row_shr:1 row_mask:0xf bank_mask:0xf
    v_mov_b32_dpp v76, v252 row_shr:1 row_mask:0xf bank_mask:0xf
    v_mov_b32_dpp v77, v253 row_shr:1 row_mask:0xf bank_mask:0xf
    v_mov_b32_dpp v78, v254 row_shr:1 row_mask:0xf bank_mask:0xf
    v_mfma_f32_16x16x32_bf16 a[12:15], v[124:127], a[152:155], a[12:15]
    ds_read_b128 a[168:171], v7 offset:13312
    v_mov_b32_dpp v79, v255 row_shr:1 row_mask:0xf bank_mask:0xf
    v_accvgpr_read_b32 v56, a0
    v_accvgpr_read_b32 v57, a1
    v_accvgpr_read_b32 v58, a2
    v_accvgpr_read_b32 v59, a3
    v_add_f32 v72, v128, v72
    v_add_f32 v73, v129, v73
    v_mfma_f32_16x16x32_bf16 a[8:11], v[120:123], a[152:155], a[8:11]
    ds_read_b128 a[172:175], v7 offset:14336
    v_add_f32 v74, v130, v74
    v_add_f32 v75, v131, v75
    v_sub_f32 v56, v56, v192
    v_sub_f32 v57, v57, v193
    v_sub_f32 v58, v58, v194
    v_sub_f32 v59, v59, v195
    v_sub_f32 v128, v56, v128
    v_mfma_f32_16x16x32_bf16 a[8:11], v[112:115], a[148:151], a[8:11]
    ds_read_b128 a[176:179], v7 offset:15360
    v_sub_f32 v129, v57, v129
    v_sub_f32 v130, v58, v130
    v_sub_f32 v131, v59, v131
    v_accvgpr_read_b32 v60, a4
    v_accvgpr_read_b32 v61, a5
    v_accvgpr_read_b32 v62, a6
    v_mfma_f32_16x16x32_bf16 a[8:11], a[188:191], a[144:147], a[8:11]
    ds_read_b64_tr_b16 v[96:97], v12 offset:6144
    v_accvgpr_read_b32 v63, a7
    v_add_f32 v76, v132, v76
    v_add_f32 v77, v133, v77
    v_add_f32 v78, v134, v78
    v_add_f32 v79, v135, v79
    v_sub_f32 v60, v60, v196
    v_sub_f32 v61, v61, v197
    v_mfma_f32_16x16x32_bf16 a[16:19], a[188:191], a[148:151], a[16:19]
    ds_read_b64_tr_b16 v[98:99], v12 offset:7168
    v_sub_f32 v62, v62, v198
    v_sub_f32 v63, v63, v199
    v_sub_f32 v132, v60, v132
    v_sub_f32 v133, v61, v133
    v_sub_f32 v134, v62, v134
    v_sub_f32 v135, v63, v135
    v_mfma_f32_16x16x32_bf16 a[16:19], v[112:115], a[152:155], a[16:19]
    s_waitcnt lgkmcnt(15)
    ds_read_b128 a[104:107], v2 offset:48128
    v_accvgpr_read_b32 v56, a8
    v_accvgpr_read_b32 v57, a9
    v_accvgpr_read_b32 v58, a10
    v_accvgpr_read_b32 v59, a11
    v_add_f32 v192, v136, v192
    v_mfma_f32_16x16x32_bf16 a[16:19], v[120:123], a[156:159], a[16:19]
    ds_read_b128 a[196:199], v2 offset:46080
    v_add_f32 v193, v137, v193
    v_add_f32 v194, v138, v194
    v_add_f32 v195, v139, v195
    v_sub_f32 v56, v56, v200
    v_sub_f32 v57, v57, v201
    v_mfma_f32_16x16x32_bf16 a[20:23], v[124:127], a[156:159], a[20:23]
    ds_read_b128 a[240:243], v3 offset:45056
    v_sub_f32 v58, v58, v202
    v_sub_f32 v59, v59, v203
    v_sub_f32 v136, v56, v136
    v_sub_f32 v137, v57, v137
    v_sub_f32 v138, v58, v138
    v_sub_f32 v139, v59, v139
    v_mfma_f32_16x16x32_bf16 a[20:23], v[116:119], a[152:155], a[20:23]
    ds_read_b128 a[244:247], v3 offset:46080
    v_accvgpr_read_b32 v60, a12
    v_accvgpr_read_b32 v61, a13
    v_accvgpr_read_b32 v62, a14
    v_accvgpr_read_b32 v63, a15
    v_add_f32 v196, v140, v196
    v_mfma_f32_16x16x32_bf16 a[20:23], a[192:195], a[148:151], a[20:23]
    ds_read_b128 a[248:251], v3 offset:47104
    v_add_f32 v197, v141, v197
    v_add_f32 v198, v142, v198
    v_add_f32 v199, v143, v199
    v_sub_f32 v60, v60, v204
    v_sub_f32 v61, v61, v205
    v_sub_f32 v62, v62, v206
    v_mfma_f32_16x16x32_bf16 a[28:31], a[192:195], a[152:155], a[28:31]
    ds_read_b128 a[252:255], v3 offset:48128
    v_sub_f32 v63, v63, v207
    v_sub_f32 v140, v60, v140
    v_sub_f32 v141, v61, v141
    v_sub_f32 v142, v62, v142
    v_sub_f32 v143, v63, v143
    v_mfma_f32_16x16x32_bf16 a[28:31], v[116:119], a[156:159], a[28:31]
    s_waitcnt lgkmcnt(15)
    ds_read_b64_tr_b16 a[200:201], v12 offset:40960
    v_accvgpr_read_b32 v56, a16
    v_accvgpr_read_b32 v57, a17
    v_accvgpr_read_b32 v58, a18
    v_accvgpr_read_b32 v59, a19
    v_add_f32 v200, v144, v200
    v_mfma_f32_16x16x32_bf16 a[28:31], v[124:127], a[160:163], a[28:31]
    ds_read_b64_tr_b16 a[202:203], v12 offset:41984
    v_add_f32 v201, v145, v201
    v_add_f32 v202, v146, v202
    v_add_f32 v203, v147, v203
    v_sub_f32 v56, v56, v208
    v_sub_f32 v57, v57, v209
    v_mfma_f32_16x16x32_bf16 a[24:27], v[120:123], a[160:163], a[24:27]
    ds_read_b64_tr_b16 a[208:209], v12 offset:43008
    v_sub_f32 v58, v58, v210
    v_sub_f32 v59, v59, v211
    v_sub_f32 v144, v56, v144
    v_sub_f32 v145, v57, v145
    v_sub_f32 v146, v58, v146
    v_sub_f32 v147, v59, v147
    v_mfma_f32_16x16x32_bf16 a[24:27], v[112:115], a[156:159], a[24:27]
    ds_read_b64_tr_b16 a[210:211], v12 offset:44032
    v_accvgpr_read_b32 v60, a20
    v_accvgpr_read_b32 v61, a21
    v_accvgpr_read_b32 v62, a22
    v_accvgpr_read_b32 v63, a23
    v_add_f32 v204, v148, v204
    v_mfma_f32_16x16x32_bf16 a[24:27], a[188:191], a[152:155], a[24:27]
    ds_read_b64_tr_b16 a[216:217], v12 offset:45056
    v_add_f32 v205, v149, v205
    v_add_f32 v206, v150, v206
    v_add_f32 v207, v151, v207
    v_sub_f32 v60, v60, v212
    v_sub_f32 v61, v61, v213
    v_sub_f32 v62, v62, v214
    v_mfma_f32_16x16x32_bf16 a[32:35], a[188:191], a[156:159], a[32:35]
    ds_read_b64_tr_b16 a[218:219], v12 offset:46080
    v_sub_f32 v63, v63, v215
    v_sub_f32 v148, v60, v148
    v_sub_f32 v149, v61, v149
    v_sub_f32 v150, v62, v150
    v_sub_f32 v151, v63, v151
    v_mfma_f32_16x16x32_bf16 a[32:35], v[112:115], a[160:163], a[32:35]
    ds_read_b64_tr_b16 a[224:225], v12 offset:47104
    v_accvgpr_read_b32 v56, a24
    v_accvgpr_read_b32 v57, a25
    v_accvgpr_read_b32 v58, a26
    v_accvgpr_read_b32 v59, a27
    v_add_f32 v208, v152, v208
    v_mfma_f32_16x16x32_bf16 a[32:35], v[120:123], a[164:167], a[32:35]
    ds_read_b64_tr_b16 a[226:227], v12 offset:48128
    v_add_f32 v209, v153, v209
    v_add_f32 v210, v154, v210
    v_add_f32 v211, v155, v211
    v_sub_f32 v56, v56, v216
    v_sub_f32 v57, v57, v217
    v_mfma_f32_16x16x32_bf16 a[36:39], v[124:127], a[164:167], a[36:39]
    ds_read_b64_tr_b16 a[232:233], v12 offset:49152
    v_sub_f32 v58, v58, v218
    v_sub_f32 v59, v59, v219
    v_sub_f32 v152, v56, v152
    v_sub_f32 v153, v57, v153
    v_sub_f32 v154, v58, v154
    v_sub_f32 v155, v59, v155
    v_mfma_f32_16x16x32_bf16 a[36:39], v[116:119], a[160:163], a[36:39]
    ds_read_b64_tr_b16 a[234:235], v12 offset:50176
    v_accvgpr_read_b32 v60, a28
    v_accvgpr_read_b32 v61, a29
    v_accvgpr_read_b32 v62, a30
    v_accvgpr_read_b32 v63, a31
    v_add_f32 v212, v156, v212
    v_mfma_f32_16x16x32_bf16 a[36:39], a[192:195], a[156:159], a[36:39]
    ds_read_b64_tr_b16 v[92:93], v13 offset:4096
    v_add_f32 v213, v157, v213
    v_add_f32 v214, v158, v214
    v_add_f32 v215, v159, v215
    v_sub_f32 v60, v60, v220
    v_sub_f32 v61, v61, v221
    v_sub_f32 v62, v62, v222
    v_mfma_f32_16x16x32_bf16 a[44:47], a[192:195], a[160:163], a[44:47]
    ds_read_b64_tr_b16 v[94:95], v13 offset:5120
    v_sub_f32 v63, v63, v223
    v_sub_f32 v156, v60, v156
    v_sub_f32 v157, v61, v157
    v_sub_f32 v158, v62, v158
    v_sub_f32 v159, v63, v159
    v_mfma_f32_16x16x32_bf16 a[44:47], v[116:119], a[164:167], a[44:47]
    s_waitcnt lgkmcnt(15)
    ds_read_b64_tr_b16 v[108:109], v13 offset:8192
    v_accvgpr_read_b32 v56, a32
    v_accvgpr_read_b32 v57, a33
    v_accvgpr_read_b32 v58, a34
    v_accvgpr_read_b32 v59, a35
    v_add_f32 v216, v160, v216
    v_mfma_f32_16x16x32_bf16 a[44:47], v[124:127], a[168:171], a[44:47]
    ds_read_b64_tr_b16 v[110:111], v13 offset:9216
    v_add_f32 v217, v161, v217
    v_add_f32 v218, v162, v218
    v_add_f32 v219, v163, v219
    v_sub_f32 v56, v56, v224
    v_sub_f32 v57, v57, v225
    v_mfma_f32_16x16x32_bf16 a[40:43], v[120:123], a[168:171], a[40:43]
    ds_read_b64_tr_b16 v[84:85], v13 offset:2048
    v_sub_f32 v58, v58, v226
    v_sub_f32 v59, v59, v227
    v_sub_f32 v160, v56, v160
    v_sub_f32 v161, v57, v161
    v_sub_f32 v162, v58, v162
    v_sub_f32 v163, v59, v163
    v_mfma_f32_16x16x32_bf16 a[40:43], v[112:115], a[164:167], a[40:43]
    ds_read_b64_tr_b16 v[86:87], v13 offset:3072
    v_accvgpr_read_b32 v60, a36
    v_accvgpr_read_b32 v61, a37
    v_accvgpr_read_b32 v62, a38
    v_accvgpr_read_b32 v63, a39
    v_add_f32 v220, v164, v220
    v_mfma_f32_16x16x32_bf16 a[40:43], a[188:191], a[160:163], a[40:43]
    ds_read_b64_tr_b16 v[100:101], v13 offset:6144
    v_add_f32 v221, v165, v221
    v_add_f32 v222, v166, v222
    v_add_f32 v223, v167, v223
    v_sub_f32 v60, v60, v228
    v_sub_f32 v61, v61, v229
    v_sub_f32 v62, v62, v230
    v_mfma_f32_16x16x32_bf16 a[48:51], a[188:191], a[164:167], a[48:51]
    ds_read_b64_tr_b16 v[102:103], v13 offset:7168
    v_sub_f32 v63, v63, v231
    v_sub_f32 v164, v60, v164
    v_sub_f32 v165, v61, v165
    v_sub_f32 v166, v62, v166
    v_sub_f32 v167, v63, v167
    v_mfma_f32_16x16x32_bf16 a[48:51], v[112:115], a[168:171], a[48:51]
    ds_read_b64_tr_b16 a[204:205], v13 offset:40960
    v_accvgpr_read_b32 v56, a40
    v_accvgpr_read_b32 v57, a41
    v_accvgpr_read_b32 v58, a42
    v_accvgpr_read_b32 v59, a43
    v_add_f32 v224, v168, v224
    v_mfma_f32_16x16x32_bf16 a[48:51], v[120:123], a[172:175], a[48:51]
    ds_read_b64_tr_b16 a[206:207], v13 offset:41984
    v_add_f32 v225, v169, v225
    v_add_f32 v226, v170, v226
    v_add_f32 v227, v171, v227
    v_sub_f32 v56, v56, v232
    v_sub_f32 v57, v57, v233
    v_mfma_f32_16x16x32_bf16 a[52:55], v[124:127], a[172:175], a[52:55]
    ds_read_b64_tr_b16 a[212:213], v13 offset:43008
    v_sub_f32 v58, v58, v234
    v_sub_f32 v59, v59, v235
    v_sub_f32 v168, v56, v168
    v_sub_f32 v169, v57, v169
    v_sub_f32 v170, v58, v170
    v_sub_f32 v171, v59, v171
    v_mfma_f32_16x16x32_bf16 a[52:55], v[116:119], a[168:171], a[52:55]
    ds_read_b64_tr_b16 a[214:215], v13 offset:44032
    v_accvgpr_read_b32 v60, a44
    v_accvgpr_read_b32 v61, a45
    v_accvgpr_read_b32 v62, a46
    v_accvgpr_read_b32 v63, a47
    v_add_f32 v228, v172, v228
    v_mfma_f32_16x16x32_bf16 a[52:55], a[192:195], a[164:167], a[52:55]
    ds_read_b64_tr_b16 a[220:221], v13 offset:45056
    v_add_f32 v229, v173, v229
    v_add_f32 v230, v174, v230
    v_add_f32 v231, v175, v231
    v_sub_f32 v60, v60, v236
    v_sub_f32 v61, v61, v237
    v_sub_f32 v62, v62, v238
    v_mfma_f32_16x16x32_bf16 a[60:63], a[192:195], a[168:171], a[60:63]
    ds_read_b64_tr_b16 a[222:223], v13 offset:46080
    v_sub_f32 v63, v63, v239
    v_sub_f32 v172, v60, v172
    v_sub_f32 v173, v61, v173
    v_sub_f32 v174, v62, v174
    v_sub_f32 v175, v63, v175
    v_mfma_f32_16x16x32_bf16 a[60:63], v[116:119], a[172:175], a[60:63]
    ds_read_b64_tr_b16 a[228:229], v13 offset:47104
    v_accvgpr_read_b32 v56, a48
    v_accvgpr_read_b32 v57, a49
    v_accvgpr_read_b32 v58, a50
    v_accvgpr_read_b32 v59, a51
    v_add_f32 v232, v176, v232
    v_add_f32 v233, v177, v233
    v_mfma_f32_16x16x32_bf16 a[60:63], v[124:127], a[176:179], a[60:63]
    ds_read_b64_tr_b16 a[230:231], v13 offset:48128
    v_add_f32 v234, v178, v234
    v_add_f32 v235, v179, v235
    v_sub_f32 v56, v56, v240
    v_sub_f32 v57, v57, v241
    v_sub_f32 v58, v58, v242
    v_sub_f32 v59, v59, v243
    v_sub_f32 v176, v56, v176
    v_mfma_f32_16x16x32_bf16 a[56:59], v[120:123], a[176:179], a[56:59]
    ds_read_b64_tr_b16 a[236:237], v13 offset:49152
    v_sub_f32 v177, v57, v177
    v_sub_f32 v178, v58, v178
    v_sub_f32 v179, v59, v179
    v_accvgpr_read_b32 v60, a52
    v_accvgpr_read_b32 v61, a53
    v_accvgpr_read_b32 v62, a54
    v_mfma_f32_16x16x32_bf16 a[56:59], v[112:115], a[172:175], a[56:59]
    ds_read_b64_tr_b16 a[238:239], v13 offset:50176
    v_accvgpr_read_b32 v63, a55
    v_add_f32 v236, v180, v236
    v_add_f32 v237, v181, v237
    v_add_f32 v238, v182, v238
    v_add_f32 v239, v183, v239
    v_sub_f32 v60, v60, v244
    v_sub_f32 v61, v61, v245
    v_mfma_f32_16x16x32_bf16 a[56:59], a[188:191], a[168:171], a[56:59]
    ds_read_b128 a[108:111], v8 offset:33792
    v_sub_f32 v62, v62, v246
    v_sub_f32 v63, v63, v247
    v_sub_f32 v180, v60, v180
    v_sub_f32 v181, v61, v181
    v_sub_f32 v182, v62, v182
    v_sub_f32 v183, v63, v183
    v_mfma_f32_16x16x32_bf16 v[72:75], a[180:183], a[64:67], v[72:75]
    ds_read_b128 a[140:143], v9 offset:32768
    v_accvgpr_read_b32 v56, a56
    v_mfma_f32_16x16x32_bf16 v[72:75], v[80:83], a[196:199], v[72:75]
    ds_read_b128 a[112:115], v8 offset:35840
    v_accvgpr_read_b32 v57, a57
    v_mfma_f32_16x16x32_bf16 v[72:75], v[88:91], a[68:71], v[72:75]
    ds_read_b128 a[144:147], v9 offset:33792
    v_accvgpr_read_b32 v58, a58
    v_mfma_f32_16x16x32_bf16 v[72:75], v[96:99], a[104:107], v[72:75]
    v_accvgpr_read_b32 v59, a59
    v_add_f32 v240, v184, v240
    v_mfma_f32_16x16x32_bf16 v[72:75], v[104:107], a[72:75], v[72:75]
    s_waitcnt lgkmcnt(15)
    v_add_f32 v241, v185, v241
    v_add_f32 v242, v186, v242
    v_mfma_f32_16x16x32_bf16 v[72:75], a[200:203], a[240:243], v[72:75]
    v_add_f32 v243, v187, v243
    v_sub_f32 v56, v56, v248
    v_mfma_f32_16x16x32_bf16 v[72:75], a[208:211], a[244:247], v[72:75]
    v_sub_f32 v57, v57, v249
    v_sub_f32 v58, v58, v250
    v_mfma_f32_16x16x32_bf16 v[72:75], a[216:219], a[248:251], v[72:75]
    v_sub_f32 v59, v59, v251
    v_sub_f32 v184, v56, v184
    v_mfma_f32_16x16x32_bf16 v[72:75], a[224:227], a[252:255], v[72:75]
    s_waitcnt lgkmcnt(2)
    v_sub_f32 v185, v57, v185
    v_sub_f32 v186, v58, v186
    v_mfma_f32_16x16x32_bf16 v[72:75], a[232:235], a[140:143], v[72:75]
    v_sub_f32 v187, v59, v187
    v_mfma_f32_16x16x32_bf16 v[76:79], a[236:239], a[140:143], v[76:79]
    v_mfma_f32_16x16x32_bf16 v[76:79], a[228:231], a[252:255], v[76:79]
    v_mfma_f32_16x16x32_bf16 v[76:79], a[220:223], a[248:251], v[76:79]
    v_mfma_f32_16x16x32_bf16 v[76:79], a[212:215], a[244:247], v[76:79]
    v_mfma_f32_16x16x32_bf16 v[76:79], a[204:207], a[240:243], v[76:79]
    v_mfma_f32_16x16x32_bf16 v[76:79], v[108:111], a[72:75], v[76:79]
    v_mfma_f32_16x16x32_bf16 v[76:79], v[100:103], a[104:107], v[76:79]
    v_mfma_f32_16x16x32_bf16 v[76:79], v[92:95], a[68:71], v[76:79]
    v_mfma_f32_16x16x32_bf16 v[76:79], v[84:87], a[196:199], v[76:79]
    v_mfma_f32_16x16x32_bf16 v[76:79], a[184:187], a[64:67], v[76:79]
    v_mfma_f32_16x16x32_bf16 v[132:135], a[184:187], a[196:199], v[132:135]
    v_mul_f32 v24, s32, v72
    v_accvgpr_read_b32 v60, a60
    v_mfma_f32_16x16x32_bf16 v[132:135], v[84:87], a[68:71], v[132:135]
    ds_read_b128 a[148:151], v9 offset:34816
    v_mul_f32 v25, s32, v73
    v_mfma_f32_16x16x32_bf16 v[132:135], v[92:95], a[104:107], v[132:135]
    v_accvgpr_read_b32 v61, a61
    v_mul_f32 v26, s32, v74
    v_mfma_f32_16x16x32_bf16 v[132:135], v[100:103], a[72:75], v[132:135]
    v_mul_f32 v27, s32, v75
    v_accvgpr_read_b32 v62, a62
    v_mfma_f32_16x16x32_bf16 v[132:135], v[108:111], a[108:111], v[132:135]
    v_mul_f32 v28, s33, v76
    v_mul_f32 v29, s33, v77
    v_mfma_f32_16x16x32_bf16 v[132:135], a[204:207], a[244:247], v[132:135]
    v_accvgpr_read_b32 v63, a63
    v_mul_f32 v30, s33, v78
    v_mfma_f32_16x16x32_bf16 v[132:135], a[212:215], a[248:251], v[132:135]
    v_mul_f32 v31, s33, v79
    v_add_f32 v244, v188, v244
    v_mfma_f32_16x16x32_bf16 v[132:135], a[220:223], a[252:255], v[132:135]
    v_min_f32 v24, s34, v24
    v_add_f32 v245, v189, v245
    v_mfma_f32_16x16x32_bf16 v[132:135], a[228:231], a[140:143], v[132:135]
    s_waitcnt lgkmcnt(1)
    v_min_f32 v25, s34, v25
    v_min_f32 v26, s34, v26
    v_mfma_f32_16x16x32_bf16 v[132:135], a[236:239], a[144:147], v[132:135]
    v_add_f32 v246, v190, v246
    v_min_f32 v27, s34, v27
    v_mfma_f32_16x16x32_bf16 v[128:131], a[232:235], a[144:147], v[128:131]
    v_exp_f32 v28, v28
    v_add_f32 v247, v191, v247
    v_mfma_f32_16x16x32_bf16 v[128:131], a[224:227], a[140:143], v[128:131]
    v_exp_f32 v29, v29
    v_mfma_f32_16x16x32_bf16 v[128:131], a[216:219], a[252:255], v[128:131]
    v_sub_f32 v60, v60, v252
    v_sub_f32 v61, v61, v253
    v_mfma_f32_16x16x32_bf16 v[128:131], a[208:211], a[248:251], v[128:131]
    v_exp_f32 v30, v30
    v_sub_f32 v62, v62, v254
    v_mfma_f32_16x16x32_bf16 v[128:131], a[200:203], a[244:247], v[128:131]
    v_exp_f32 v31, v31
    v_sub_f32 v63, v63, v255
    v_mfma_f32_16x16x32_bf16 v[128:131], v[104:107], a[108:111], v[128:131]
    v_exp_f32 v24, v24
    v_mfma_f32_16x16x32_bf16 v[128:131], v[96:99], a[72:75], v[128:131]
    v_sub_f32 v188, v60, v188
    v_exp_f32 v25, v25
    v_mfma_f32_16x16x32_bf16 v[128:131], v[88:91], a[104:107], v[128:131]
    v_sub_f32 v189, v61, v189
    v_exp_f32 v26, v26
    v_mfma_f32_16x16x32_bf16 v[128:131], v[80:83], a[68:71], v[128:131]
    v_sub_f32 v190, v62, v190
    v_exp_f32 v27, v27
    v_mfma_f32_16x16x32_bf16 v[128:131], a[180:183], a[196:199], v[128:131]
    v_sub_f32 v191, v63, v191
    v_mfma_f32_16x16x32_bf16 v[192:195], a[180:183], a[68:71], v[192:195]
    v_mul_f32 v36, s33, v132
    v_add_f32 v40, 1.0, v24
    v_mul_f32 v37, s33, v133
    v_mfma_f32_16x16x32_bf16 v[192:195], v[80:83], a[104:107], v[192:195]
    ds_read_b128 a[116:119], v8 offset:37888
    v_add_f32 v41, 1.0, v25
    v_mul_f32 v38, s33, v134
    v_mfma_f32_16x16x32_bf16 v[192:195], v[88:91], a[72:75], v[192:195]
    ds_read_b128 a[152:155], v9 offset:35840
    v_add_f32 v42, 1.0, v26
    v_mul_f32 v39, s33, v135
    v_mfma_f32_16x16x32_bf16 v[192:195], v[96:99], a[108:111], v[192:195]
    v_add_f32 v43, 1.0, v27
    v_mul_f32 v32, s32, v128
    v_mul_f32 v33, s32, v129
    v_mfma_f32_16x16x32_bf16 v[192:195], v[104:107], a[76:79], v[192:195]
    v_fma_f32 v40, v40, v28, v40
    v_mul_f32 v34, s32, v130
    v_fma_f32 v41, v41, v29, v41
    v_mfma_f32_16x16x32_bf16 v[192:195], a[200:203], a[248:251], v[192:195]
    v_mul_f32 v35, s32, v131
    v_fma_f32 v42, v42, v30, v42
    v_mfma_f32_16x16x32_bf16 v[192:195], a[208:211], a[252:255], v[192:195]
    v_min_f32 v32, s34, v32
    v_fma_f32 v43, v43, v31, v43
    v_min_f32 v33, s34, v33
    v_mfma_f32_16x16x32_bf16 v[192:195], a[216:219], a[140:143], v[192:195]
    v_min_f32 v34, s34, v34
    v_rcp_f32 v40, v40
    v_mfma_f32_16x16x32_bf16 v[192:195], a[224:227], a[144:147], v[192:195]
    s_waitcnt lgkmcnt(2)
    v_min_f32 v35, s34, v35
    v_exp_f32 v36, v36
    v_mfma_f32_16x16x32_bf16 v[192:195], a[232:235], a[148:151], v[192:195]
    v_rcp_f32 v41, v41
    v_mfma_f32_16x16x32_bf16 v[196:199], a[236:239], a[148:151], v[196:199]
    v_exp_f32 v37, v37
    v_mfma_f32_16x16x32_bf16 v[196:199], a[228:231], a[144:147], v[196:199]
    v_rcp_f32 v42, v42
    v_mfma_f32_16x16x32_bf16 v[196:199], a[220:223], a[140:143], v[196:199]
    v_exp_f32 v38, v38
    v_mfma_f32_16x16x32_bf16 v[196:199], a[212:215], a[252:255], v[196:199]
    v_rcp_f32 v43, v43
    v_mfma_f32_16x16x32_bf16 v[196:199], a[204:207], a[248:251], v[196:199]
    v_exp_f32 v39, v39
    v_mfma_f32_16x16x32_bf16 v[196:199], v[108:111], a[76:79], v[196:199]
    v_exp_f32 v32, v32
    v_fma_f32 v24, v24, v40, -v40
    v_mfma_f32_16x16x32_bf16 v[196:199], v[100:103], a[108:111], v[196:199]
    v_fma_f32 v25, v25, v41, -v41
    v_exp_f32 v33, v33
    v_mfma_f32_16x16x32_bf16 v[196:199], v[92:95], a[72:75], v[196:199]
    v_fma_f32 v26, v26, v42, -v42
    v_exp_f32 v34, v34
    v_mfma_f32_16x16x32_bf16 v[196:199], v[84:87], a[104:107], v[196:199]
    v_fma_f32 v27, v27, v43, -v43
    v_cvt_pk_bf16_f32 v44, v24, v25
    v_mfma_f32_16x16x32_bf16 v[196:199], a[184:187], a[68:71], v[196:199]
    v_exp_f32 v35, v35
    v_cvt_pk_bf16_f32 v45, v26, v27
    v_mfma_f32_16x16x32_bf16 v[140:143], a[184:187], a[104:107], v[140:143]
    v_mul_f32 v24, s32, v192
    v_add_f32 v40, 1.0, v32
    v_mul_f32 v25, s32, v193
    v_mfma_f32_16x16x32_bf16 v[140:143], v[84:87], a[72:75], v[140:143]
    ds_read_b128 a[156:159], v9 offset:36864
    v_add_f32 v41, 1.0, v33
    v_mul_f32 v26, s32, v194
    v_mfma_f32_16x16x32_bf16 v[140:143], v[92:95], a[108:111], v[140:143]
    v_add_f32 v42, 1.0, v34
    v_mul_f32 v27, s32, v195
    v_add_f32 v43, 1.0, v35
    v_mfma_f32_16x16x32_bf16 v[140:143], v[100:103], a[76:79], v[140:143]
    v_mul_f32 v28, s33, v196
    v_mul_f32 v29, s33, v197
    v_mfma_f32_16x16x32_bf16 v[140:143], v[108:111], a[112:115], v[140:143]
    v_fma_f32 v40, v40, v36, v40
    v_mul_f32 v30, s33, v198
    v_fma_f32 v41, v41, v37, v41
    v_mfma_f32_16x16x32_bf16 v[140:143], a[204:207], a[252:255], v[140:143]
    v_mul_f32 v31, s33, v199
    v_fma_f32 v42, v42, v38, v42
    v_mfma_f32_16x16x32_bf16 v[140:143], a[212:215], a[140:143], v[140:143]
    v_min_f32 v24, s34, v24
    v_fma_f32 v43, v43, v39, v43
    v_min_f32 v25, s34, v25
    v_mfma_f32_16x16x32_bf16 v[140:143], a[220:223], a[144:147], v[140:143]
    v_min_f32 v26, s34, v26
    v_rcp_f32 v40, v40
    v_mfma_f32_16x16x32_bf16 v[140:143], a[228:231], a[148:151], v[140:143]
    s_waitcnt lgkmcnt(1)
    v_min_f32 v27, s34, v27
    v_exp_f32 v28, v28
    v_mfma_f32_16x16x32_bf16 v[140:143], a[236:239], a[152:155], v[140:143]
    v_rcp_f32 v41, v41
    v_mfma_f32_16x16x32_bf16 v[136:139], a[232:235], a[152:155], v[136:139]
    v_exp_f32 v29, v29
    v_mfma_f32_16x16x32_bf16 v[136:139], a[224:227], a[148:151], v[136:139]
    v_rcp_f32 v42, v42
    v_mfma_f32_16x16x32_bf16 v[136:139], a[216:219], a[144:147], v[136:139]
    v_exp_f32 v30, v30
    v_mfma_f32_16x16x32_bf16 v[136:139], a[208:211], a[140:143], v[136:139]
    v_rcp_f32 v43, v43
    v_mfma_f32_16x16x32_bf16 v[136:139], a[200:203], a[252:255], v[136:139]
    v_exp_f32 v31, v31
    v_mfma_f32_16x16x32_bf16 v[136:139], v[104:107], a[112:115], v[136:139]
    v_exp_f32 v24, v24
    v_fma_f32 v32, v32, v40, -v40
    v_mfma_f32_16x16x32_bf16 v[136:139], v[96:99], a[76:79], v[136:139]
    v_fma_f32 v33, v33, v41, -v41
    v_exp_f32 v25, v25
    v_mfma_f32_16x16x32_bf16 v[136:139], v[88:91], a[108:111], v[136:139]
    v_fma_f32 v34, v34, v42, -v42
    v_exp_f32 v26, v26
    v_mfma_f32_16x16x32_bf16 v[136:139], v[80:83], a[72:75], v[136:139]
    v_fma_f32 v35, v35, v43, -v43
    v_cvt_pk_bf16_f32 v46, v32, v33
    v_mfma_f32_16x16x32_bf16 v[136:139], a[180:183], a[104:107], v[136:139]
    v_exp_f32 v27, v27
    v_cvt_pk_bf16_f32 v47, v34, v35
    v_mfma_f32_16x16x32_bf16 v[200:203], a[180:183], a[72:75], v[200:203]
    s_mov_b32 s63, 0
    v_permlane16_swap_b32 v44, v46
    v_permlane16_swap_b32 v45, v47
    v_mfma_f32_16x16x32_bf16 v[200:203], v[80:83], a[108:111], v[200:203]
    ds_read_b128 a[120:123], v8 offset:39936
    v_mul_f32 v36, s33, v140
    v_add_f32 v40, 1.0, v24
    v_mfma_f32_16x16x32_bf16 v[200:203], v[88:91], a[76:79], v[200:203]
    ds_read_b128 a[160:163], v9 offset:37888
    v_mul_f32 v37, s33, v141
    v_add_f32 v41, 1.0, v25
    v_mfma_f32_16x16x32_bf16 v[200:203], v[96:99], a[112:115], v[200:203]
    buffer_store_dwordx4 v[44:47], v16, s[12:15], s63 offen
    v_mfma_f32_16x16x32_bf16 v[200:203], v[104:107], a[80:83], v[200:203]
    v_mul_f32 v38, s33, v142
    v_add_f32 v42, 1.0, v26
    v_mul_f32 v39, s33, v143
    v_mfma_f32_16x16x32_bf16 v[200:203], a[200:203], a[140:143], v[200:203]
    v_add_f32 v43, 1.0, v27
    v_mul_f32 v32, s32, v136
    v_mul_f32 v33, s32, v137
    v_mfma_f32_16x16x32_bf16 v[200:203], a[208:211], a[144:147], v[200:203]
    v_fma_f32 v40, v40, v28, v40
    v_mul_f32 v34, s32, v138
    v_fma_f32 v41, v41, v29, v41
    v_mfma_f32_16x16x32_bf16 v[200:203], a[216:219], a[148:151], v[200:203]
    v_mul_f32 v35, s32, v139
    v_fma_f32 v42, v42, v30, v42
    v_min_f32 v32, s34, v32
    v_mfma_f32_16x16x32_bf16 v[200:203], a[224:227], a[152:155], v[200:203]
    s_waitcnt lgkmcnt(2)
    v_fma_f32 v43, v43, v31, v43
    v_min_f32 v33, s34, v33
    v_min_f32 v34, s34, v34
    v_mfma_f32_16x16x32_bf16 v[200:203], a[232:235], a[156:159], v[200:203]
    v_rcp_f32 v40, v40
    v_min_f32 v35, s34, v35
    v_mfma_f32_16x16x32_bf16 v[204:207], a[236:239], a[156:159], v[204:207]
    v_exp_f32 v36, v36
    v_mfma_f32_16x16x32_bf16 v[204:207], a[228:231], a[152:155], v[204:207]
    v_rcp_f32 v41, v41
    v_mfma_f32_16x16x32_bf16 v[204:207], a[220:223], a[148:151], v[204:207]
    v_exp_f32 v37, v37
    v_mfma_f32_16x16x32_bf16 v[204:207], a[212:215], a[144:147], v[204:207]
    v_rcp_f32 v42, v42
    v_mfma_f32_16x16x32_bf16 v[204:207], a[204:207], a[140:143], v[204:207]
    v_exp_f32 v38, v38
    v_mfma_f32_16x16x32_bf16 v[204:207], v[108:111], a[80:83], v[204:207]
    v_rcp_f32 v43, v43
    v_exp_f32 v39, v39
    v_mfma_f32_16x16x32_bf16 v[204:207], v[100:103], a[112:115], v[204:207]
    v_exp_f32 v32, v32
    v_fma_f32 v24, v24, v40, -v40
    v_fma_f32 v25, v25, v41, -v41
    v_mfma_f32_16x16x32_bf16 v[204:207], v[92:95], a[76:79], v[204:207]
    v_exp_f32 v33, v33
    v_fma_f32 v26, v26, v42, -v42
    v_mfma_f32_16x16x32_bf16 v[204:207], v[84:87], a[108:111], v[204:207]
    v_exp_f32 v34, v34
    v_fma_f32 v27, v27, v43, -v43
    v_cvt_pk_bf16_f32 v48, v24, v25
    v_mfma_f32_16x16x32_bf16 v[204:207], a[184:187], a[72:75], v[204:207]
    v_exp_f32 v35, v35
    v_cvt_pk_bf16_f32 v49, v26, v27
    v_mfma_f32_16x16x32_bf16 v[148:151], a[184:187], a[108:111], v[148:151]
    v_mul_f32 v24, s32, v200
    v_add_f32 v40, 1.0, v32
    v_mul_f32 v25, s32, v201
    v_mfma_f32_16x16x32_bf16 v[148:151], v[84:87], a[76:79], v[148:151]
    ds_read_b128 a[164:167], v9 offset:38912
    v_add_f32 v41, 1.0, v33
    v_mul_f32 v26, s32, v202
    v_mfma_f32_16x16x32_bf16 v[148:151], v[92:95], a[112:115], v[148:151]
    v_add_f32 v42, 1.0, v34
    v_mul_f32 v27, s32, v203
    v_add_f32 v43, 1.0, v35
    v_mfma_f32_16x16x32_bf16 v[148:151], v[100:103], a[80:83], v[148:151]
    v_mul_f32 v28, s33, v204
    v_mul_f32 v29, s33, v205
    v_mfma_f32_16x16x32_bf16 v[148:151], v[108:111], a[116:119], v[148:151]
    v_fma_f32 v40, v40, v36, v40
    v_mul_f32 v30, s33, v206
    v_fma_f32 v41, v41, v37, v41
    v_mfma_f32_16x16x32_bf16 v[148:151], a[204:207], a[144:147], v[148:151]
    v_mul_f32 v31, s33, v207
    v_fma_f32 v42, v42, v38, v42
    v_mfma_f32_16x16x32_bf16 v[148:151], a[212:215], a[148:151], v[148:151]
    v_min_f32 v24, s34, v24
    v_fma_f32 v43, v43, v39, v43
    v_min_f32 v25, s34, v25
    v_mfma_f32_16x16x32_bf16 v[148:151], a[220:223], a[152:155], v[148:151]
    v_min_f32 v26, s34, v26
    v_rcp_f32 v40, v40
    v_mfma_f32_16x16x32_bf16 v[148:151], a[228:231], a[156:159], v[148:151]
    s_waitcnt lgkmcnt(1)
    v_min_f32 v27, s34, v27
    v_exp_f32 v28, v28
    v_mfma_f32_16x16x32_bf16 v[148:151], a[236:239], a[160:163], v[148:151]
    v_rcp_f32 v41, v41
    v_mfma_f32_16x16x32_bf16 v[144:147], a[232:235], a[160:163], v[144:147]
    v_exp_f32 v29, v29
    v_mfma_f32_16x16x32_bf16 v[144:147], a[224:227], a[156:159], v[144:147]
    v_rcp_f32 v42, v42
    v_mfma_f32_16x16x32_bf16 v[144:147], a[216:219], a[152:155], v[144:147]
    v_exp_f32 v30, v30
    v_mfma_f32_16x16x32_bf16 v[144:147], a[208:211], a[148:151], v[144:147]
    v_rcp_f32 v43, v43
    v_mfma_f32_16x16x32_bf16 v[144:147], a[200:203], a[144:147], v[144:147]
    v_exp_f32 v31, v31
    v_mfma_f32_16x16x32_bf16 v[144:147], v[104:107], a[116:119], v[144:147]
    v_exp_f32 v24, v24
    v_fma_f32 v32, v32, v40, -v40
    v_mfma_f32_16x16x32_bf16 v[144:147], v[96:99], a[80:83], v[144:147]
    v_fma_f32 v33, v33, v41, -v41
    v_exp_f32 v25, v25
    v_mfma_f32_16x16x32_bf16 v[144:147], v[88:91], a[112:115], v[144:147]
    v_fma_f32 v34, v34, v42, -v42
    v_exp_f32 v26, v26
    v_mfma_f32_16x16x32_bf16 v[144:147], v[80:83], a[76:79], v[144:147]
    v_fma_f32 v35, v35, v43, -v43
    v_cvt_pk_bf16_f32 v50, v32, v33
    v_mfma_f32_16x16x32_bf16 v[144:147], a[180:183], a[108:111], v[144:147]
    v_exp_f32 v27, v27
    v_cvt_pk_bf16_f32 v51, v34, v35
    v_mfma_f32_16x16x32_bf16 v[208:211], a[180:183], a[76:79], v[208:211]
    s_mov_b32 s63, 4096
    v_permlane16_swap_b32 v48, v50
    v_permlane16_swap_b32 v49, v51
    v_mfma_f32_16x16x32_bf16 v[208:211], v[80:83], a[112:115], v[208:211]
    ds_read_b128 a[124:127], v8 offset:41984
    v_mul_f32 v36, s33, v148
    v_add_f32 v40, 1.0, v24
    v_mfma_f32_16x16x32_bf16 v[208:211], v[88:91], a[80:83], v[208:211]
    ds_read_b128 a[168:171], v9 offset:39936
    v_mul_f32 v37, s33, v149
    v_add_f32 v41, 1.0, v25
    v_mfma_f32_16x16x32_bf16 v[208:211], v[96:99], a[116:119], v[208:211]
    buffer_store_dwordx4 v[48:51], v16, s[12:15], s63 offen
    v_mfma_f32_16x16x32_bf16 v[208:211], v[104:107], a[84:87], v[208:211]
    v_mul_f32 v38, s33, v150
    v_add_f32 v42, 1.0, v26
    v_mul_f32 v39, s33, v151
    v_mfma_f32_16x16x32_bf16 v[208:211], a[200:203], a[148:151], v[208:211]
    v_add_f32 v43, 1.0, v27
    v_mul_f32 v32, s32, v144
    v_mul_f32 v33, s32, v145
    v_mfma_f32_16x16x32_bf16 v[208:211], a[208:211], a[152:155], v[208:211]
    v_fma_f32 v40, v40, v28, v40
    v_mul_f32 v34, s32, v146
    v_fma_f32 v41, v41, v29, v41
    v_mfma_f32_16x16x32_bf16 v[208:211], a[216:219], a[156:159], v[208:211]
    v_mul_f32 v35, s32, v147
    v_fma_f32 v42, v42, v30, v42
    v_min_f32 v32, s34, v32
    v_mfma_f32_16x16x32_bf16 v[208:211], a[224:227], a[160:163], v[208:211]
    s_waitcnt lgkmcnt(2)
    v_fma_f32 v43, v43, v31, v43
    v_min_f32 v33, s34, v33
    v_min_f32 v34, s34, v34
    v_mfma_f32_16x16x32_bf16 v[208:211], a[232:235], a[164:167], v[208:211]
    v_rcp_f32 v40, v40
    v_min_f32 v35, s34, v35
    v_mfma_f32_16x16x32_bf16 v[212:215], a[236:239], a[164:167], v[212:215]
    v_exp_f32 v36, v36
    v_mfma_f32_16x16x32_bf16 v[212:215], a[228:231], a[160:163], v[212:215]
    v_rcp_f32 v41, v41
    v_mfma_f32_16x16x32_bf16 v[212:215], a[220:223], a[156:159], v[212:215]
    v_exp_f32 v37, v37
    v_mfma_f32_16x16x32_bf16 v[212:215], a[212:215], a[152:155], v[212:215]
    v_rcp_f32 v42, v42
    v_mfma_f32_16x16x32_bf16 v[212:215], a[204:207], a[148:151], v[212:215]
    v_exp_f32 v38, v38
    v_mfma_f32_16x16x32_bf16 v[212:215], v[108:111], a[84:87], v[212:215]
    v_rcp_f32 v43, v43
    v_exp_f32 v39, v39
    v_mfma_f32_16x16x32_bf16 v[212:215], v[100:103], a[116:119], v[212:215]
    v_exp_f32 v32, v32
    v_fma_f32 v24, v24, v40, -v40
    v_fma_f32 v25, v25, v41, -v41
    v_mfma_f32_16x16x32_bf16 v[212:215], v[92:95], a[80:83], v[212:215]
    v_exp_f32 v33, v33
    v_fma_f32 v26, v26, v42, -v42
    v_mfma_f32_16x16x32_bf16 v[212:215], v[84:87], a[112:115], v[212:215]
    v_exp_f32 v34, v34
    v_fma_f32 v27, v27, v43, -v43
    v_cvt_pk_bf16_f32 v44, v24, v25
    v_mfma_f32_16x16x32_bf16 v[212:215], a[184:187], a[76:79], v[212:215]
    v_exp_f32 v35, v35
    v_cvt_pk_bf16_f32 v45, v26, v27
    v_mfma_f32_16x16x32_bf16 v[156:159], a[184:187], a[112:115], v[156:159]
    v_mul_f32 v24, s32, v208
    v_add_f32 v40, 1.0, v32
    v_mul_f32 v25, s32, v209
    v_mfma_f32_16x16x32_bf16 v[156:159], v[84:87], a[80:83], v[156:159]
    ds_read_b128 a[172:175], v9 offset:40960
    v_add_f32 v41, 1.0, v33
    v_mul_f32 v26, s32, v210
    v_mfma_f32_16x16x32_bf16 v[156:159], v[92:95], a[116:119], v[156:159]
    v_add_f32 v42, 1.0, v34
    v_mul_f32 v27, s32, v211
    v_add_f32 v43, 1.0, v35
    v_mfma_f32_16x16x32_bf16 v[156:159], v[100:103], a[84:87], v[156:159]
    v_mul_f32 v28, s33, v212
    v_mul_f32 v29, s33, v213
    v_mfma_f32_16x16x32_bf16 v[156:159], v[108:111], a[120:123], v[156:159]
    v_fma_f32 v40, v40, v36, v40
    v_mul_f32 v30, s33, v214
    v_fma_f32 v41, v41, v37, v41
    v_mfma_f32_16x16x32_bf16 v[156:159], a[204:207], a[152:155], v[156:159]
    v_mul_f32 v31, s33, v215
    v_fma_f32 v42, v42, v38, v42
    v_mfma_f32_16x16x32_bf16 v[156:159], a[212:215], a[156:159], v[156:159]
    v_min_f32 v24, s34, v24
    v_fma_f32 v43, v43, v39, v43
    v_min_f32 v25, s34, v25
    v_mfma_f32_16x16x32_bf16 v[156:159], a[220:223], a[160:163], v[156:159]
    v_min_f32 v26, s34, v26
    v_rcp_f32 v40, v40
    v_mfma_f32_16x16x32_bf16 v[156:159], a[228:231], a[164:167], v[156:159]
    s_waitcnt lgkmcnt(1)
    v_min_f32 v27, s34, v27
    v_exp_f32 v28, v28
    v_mfma_f32_16x16x32_bf16 v[156:159], a[236:239], a[168:171], v[156:159]
    v_rcp_f32 v41, v41
    v_mfma_f32_16x16x32_bf16 v[152:155], a[232:235], a[168:171], v[152:155]
    v_exp_f32 v29, v29
    v_mfma_f32_16x16x32_bf16 v[152:155], a[224:227], a[164:167], v[152:155]
    v_rcp_f32 v42, v42
    v_mfma_f32_16x16x32_bf16 v[152:155], a[216:219], a[160:163], v[152:155]
    v_exp_f32 v30, v30
    v_mfma_f32_16x16x32_bf16 v[152:155], a[208:211], a[156:159], v[152:155]
    v_rcp_f32 v43, v43
    v_mfma_f32_16x16x32_bf16 v[152:155], a[200:203], a[152:155], v[152:155]
    v_exp_f32 v31, v31
    v_mfma_f32_16x16x32_bf16 v[152:155], v[104:107], a[120:123], v[152:155]
    v_exp_f32 v24, v24
    v_fma_f32 v32, v32, v40, -v40
    v_mfma_f32_16x16x32_bf16 v[152:155], v[96:99], a[84:87], v[152:155]
    v_fma_f32 v33, v33, v41, -v41
    v_exp_f32 v25, v25
    v_mfma_f32_16x16x32_bf16 v[152:155], v[88:91], a[116:119], v[152:155]
    v_fma_f32 v34, v34, v42, -v42
    v_exp_f32 v26, v26
    v_mfma_f32_16x16x32_bf16 v[152:155], v[80:83], a[80:83], v[152:155]
    v_fma_f32 v35, v35, v43, -v43
    v_cvt_pk_bf16_f32 v46, v32, v33
    v_mfma_f32_16x16x32_bf16 v[152:155], a[180:183], a[112:115], v[152:155]
    v_exp_f32 v27, v27
    v_cvt_pk_bf16_f32 v47, v34, v35
    v_mfma_f32_16x16x32_bf16 v[216:219], a[180:183], a[80:83], v[216:219]
    s_mov_b32 s63, 0
    v_permlane16_swap_b32 v44, v46
    v_permlane16_swap_b32 v45, v47
    v_mfma_f32_16x16x32_bf16 v[216:219], v[80:83], a[116:119], v[216:219]
    ds_read_b128 a[128:131], v8 offset:44032
    v_mul_f32 v36, s33, v156
    v_add_f32 v40, 1.0, v24
    v_mfma_f32_16x16x32_bf16 v[216:219], v[88:91], a[84:87], v[216:219]
    ds_read_b128 a[176:179], v9 offset:41984
    v_mul_f32 v37, s33, v157
    v_add_f32 v41, 1.0, v25
    v_mfma_f32_16x16x32_bf16 v[216:219], v[96:99], a[120:123], v[216:219]
    buffer_store_dwordx4 v[44:47], v17, s[12:15], s63 offen
    v_mfma_f32_16x16x32_bf16 v[216:219], v[104:107], a[88:91], v[216:219]
    v_mul_f32 v38, s33, v158
    v_add_f32 v42, 1.0, v26
    v_mul_f32 v39, s33, v159
    v_mfma_f32_16x16x32_bf16 v[216:219], a[200:203], a[156:159], v[216:219]
    v_add_f32 v43, 1.0, v27
    v_mul_f32 v32, s32, v152
    v_mul_f32 v33, s32, v153
    v_mfma_f32_16x16x32_bf16 v[216:219], a[208:211], a[160:163], v[216:219]
    v_fma_f32 v40, v40, v28, v40
    v_mul_f32 v34, s32, v154
    v_fma_f32 v41, v41, v29, v41
    v_mfma_f32_16x16x32_bf16 v[216:219], a[216:219], a[164:167], v[216:219]
    v_mul_f32 v35, s32, v155
    v_fma_f32 v42, v42, v30, v42
    v_min_f32 v32, s34, v32
    v_mfma_f32_16x16x32_bf16 v[216:219], a[224:227], a[168:171], v[216:219]
    s_waitcnt lgkmcnt(2)
    v_fma_f32 v43, v43, v31, v43
    v_min_f32 v33, s34, v33
    v_min_f32 v34, s34, v34
    v_mfma_f32_16x16x32_bf16 v[216:219], a[232:235], a[172:175], v[216:219]
    v_rcp_f32 v40, v40
    v_min_f32 v35, s34, v35
    v_mfma_f32_16x16x32_bf16 v[220:223], a[236:239], a[172:175], v[220:223]
    v_exp_f32 v36, v36
    v_mfma_f32_16x16x32_bf16 v[220:223], a[228:231], a[168:171], v[220:223]
    v_rcp_f32 v41, v41
    v_mfma_f32_16x16x32_bf16 v[220:223], a[220:223], a[164:167], v[220:223]
    v_exp_f32 v37, v37
    v_mfma_f32_16x16x32_bf16 v[220:223], a[212:215], a[160:163], v[220:223]
    v_rcp_f32 v42, v42
    v_mfma_f32_16x16x32_bf16 v[220:223], a[204:207], a[156:159], v[220:223]
    v_exp_f32 v38, v38
    v_mfma_f32_16x16x32_bf16 v[220:223], v[108:111], a[88:91], v[220:223]
    v_rcp_f32 v43, v43
    v_exp_f32 v39, v39
    v_mfma_f32_16x16x32_bf16 v[220:223], v[100:103], a[120:123], v[220:223]
    v_exp_f32 v32, v32
    v_fma_f32 v24, v24, v40, -v40
    v_fma_f32 v25, v25, v41, -v41
    v_mfma_f32_16x16x32_bf16 v[220:223], v[92:95], a[84:87], v[220:223]
    v_exp_f32 v33, v33
    v_fma_f32 v26, v26, v42, -v42
    v_mfma_f32_16x16x32_bf16 v[220:223], v[84:87], a[116:119], v[220:223]
    v_exp_f32 v34, v34
    v_fma_f32 v27, v27, v43, -v43
    v_cvt_pk_bf16_f32 v48, v24, v25
    v_mfma_f32_16x16x32_bf16 v[220:223], a[184:187], a[80:83], v[220:223]
    v_exp_f32 v35, v35
    v_cvt_pk_bf16_f32 v49, v26, v27
    v_mfma_f32_16x16x32_bf16 v[164:167], a[184:187], a[116:119], v[164:167]
    v_mul_f32 v24, s32, v216
    v_add_f32 v40, 1.0, v32
    v_mul_f32 v25, s32, v217
    v_mfma_f32_16x16x32_bf16 v[164:167], v[84:87], a[84:87], v[164:167]
    ds_read_b128 a[240:243], v9 offset:43008
    v_add_f32 v41, 1.0, v33
    v_mul_f32 v26, s32, v218
    v_mfma_f32_16x16x32_bf16 v[164:167], v[92:95], a[120:123], v[164:167]
    v_add_f32 v42, 1.0, v34
    v_mul_f32 v27, s32, v219
    v_add_f32 v43, 1.0, v35
    v_mfma_f32_16x16x32_bf16 v[164:167], v[100:103], a[88:91], v[164:167]
    v_mul_f32 v28, s33, v220
    v_mul_f32 v29, s33, v221
    v_mfma_f32_16x16x32_bf16 v[164:167], v[108:111], a[124:127], v[164:167]
    v_fma_f32 v40, v40, v36, v40
    v_mul_f32 v30, s33, v222
    v_fma_f32 v41, v41, v37, v41
    v_mfma_f32_16x16x32_bf16 v[164:167], a[204:207], a[160:163], v[164:167]
    v_mul_f32 v31, s33, v223
    v_fma_f32 v42, v42, v38, v42
    v_mfma_f32_16x16x32_bf16 v[164:167], a[212:215], a[164:167], v[164:167]
    v_min_f32 v24, s34, v24
    v_fma_f32 v43, v43, v39, v43
    v_min_f32 v25, s34, v25
    v_mfma_f32_16x16x32_bf16 v[164:167], a[220:223], a[168:171], v[164:167]
    v_min_f32 v26, s34, v26
    v_rcp_f32 v40, v40
    v_mfma_f32_16x16x32_bf16 v[164:167], a[228:231], a[172:175], v[164:167]
    s_waitcnt lgkmcnt(1)
    v_min_f32 v27, s34, v27
    v_exp_f32 v28, v28
    v_mfma_f32_16x16x32_bf16 v[164:167], a[236:239], a[176:179], v[164:167]
    v_rcp_f32 v41, v41
    v_mfma_f32_16x16x32_bf16 v[160:163], a[232:235], a[176:179], v[160:163]
    v_exp_f32 v29, v29
    v_mfma_f32_16x16x32_bf16 v[160:163], a[224:227], a[172:175], v[160:163]
    v_rcp_f32 v42, v42
    v_mfma_f32_16x16x32_bf16 v[160:163], a[216:219], a[168:171], v[160:163]
    v_exp_f32 v30, v30
    v_mfma_f32_16x16x32_bf16 v[160:163], a[208:211], a[164:167], v[160:163]
    v_rcp_f32 v43, v43
    v_mfma_f32_16x16x32_bf16 v[160:163], a[200:203], a[160:163], v[160:163]
    v_exp_f32 v31, v31
    v_mfma_f32_16x16x32_bf16 v[160:163], v[104:107], a[124:127], v[160:163]
    v_exp_f32 v24, v24
    v_fma_f32 v32, v32, v40, -v40
    v_mfma_f32_16x16x32_bf16 v[160:163], v[96:99], a[88:91], v[160:163]
    v_fma_f32 v33, v33, v41, -v41
    v_exp_f32 v25, v25
    v_mfma_f32_16x16x32_bf16 v[160:163], v[88:91], a[120:123], v[160:163]
    v_fma_f32 v34, v34, v42, -v42
    v_exp_f32 v26, v26
    v_mfma_f32_16x16x32_bf16 v[160:163], v[80:83], a[84:87], v[160:163]
    v_fma_f32 v35, v35, v43, -v43
    v_cvt_pk_bf16_f32 v50, v32, v33
    v_mfma_f32_16x16x32_bf16 v[160:163], a[180:183], a[116:119], v[160:163]
    v_exp_f32 v27, v27
    v_cvt_pk_bf16_f32 v51, v34, v35
    v_mfma_f32_16x16x32_bf16 v[224:227], a[180:183], a[84:87], v[224:227]
    s_mov_b32 s63, 4096
    v_permlane16_swap_b32 v48, v50
    v_permlane16_swap_b32 v49, v51
    v_mfma_f32_16x16x32_bf16 v[224:227], v[80:83], a[120:123], v[224:227]
    ds_read_b128 a[132:135], v8 offset:46080
    v_mul_f32 v36, s33, v164
    v_add_f32 v40, 1.0, v24
    v_mfma_f32_16x16x32_bf16 v[224:227], v[88:91], a[88:91], v[224:227]
    ds_read_b128 a[244:247], v9 offset:44032
    v_mul_f32 v37, s33, v165
    v_add_f32 v41, 1.0, v25
    v_mfma_f32_16x16x32_bf16 v[224:227], v[96:99], a[124:127], v[224:227]
    buffer_store_dwordx4 v[48:51], v17, s[12:15], s63 offen
    v_mfma_f32_16x16x32_bf16 v[224:227], v[104:107], a[92:95], v[224:227]
    v_mul_f32 v38, s33, v166
    v_add_f32 v42, 1.0, v26
    v_mul_f32 v39, s33, v167
    v_mfma_f32_16x16x32_bf16 v[224:227], a[200:203], a[164:167], v[224:227]
    v_add_f32 v43, 1.0, v27
    v_mul_f32 v32, s32, v160
    v_mul_f32 v33, s32, v161
    v_mfma_f32_16x16x32_bf16 v[224:227], a[208:211], a[168:171], v[224:227]
    v_fma_f32 v40, v40, v28, v40
    v_mul_f32 v34, s32, v162
    v_fma_f32 v41, v41, v29, v41
    v_mfma_f32_16x16x32_bf16 v[224:227], a[216:219], a[172:175], v[224:227]
    v_mul_f32 v35, s32, v163
    v_fma_f32 v42, v42, v30, v42
    v_min_f32 v32, s34, v32
    v_mfma_f32_16x16x32_bf16 v[224:227], a[224:227], a[176:179], v[224:227]
    s_waitcnt lgkmcnt(2)
    v_fma_f32 v43, v43, v31, v43
    v_min_f32 v33, s34, v33
    v_min_f32 v34, s34, v34
    v_mfma_f32_16x16x32_bf16 v[224:227], a[232:235], a[240:243], v[224:227]
    v_rcp_f32 v40, v40
    v_min_f32 v35, s34, v35
    v_mfma_f32_16x16x32_bf16 v[228:231], a[236:239], a[240:243], v[228:231]
    v_exp_f32 v36, v36
    v_mfma_f32_16x16x32_bf16 v[228:231], a[228:231], a[176:179], v[228:231]
    v_rcp_f32 v41, v41
    v_mfma_f32_16x16x32_bf16 v[228:231], a[220:223], a[172:175], v[228:231]
    v_exp_f32 v37, v37
    v_mfma_f32_16x16x32_bf16 v[228:231], a[212:215], a[168:171], v[228:231]
    v_rcp_f32 v42, v42
    v_mfma_f32_16x16x32_bf16 v[228:231], a[204:207], a[164:167], v[228:231]
    v_exp_f32 v38, v38
    v_mfma_f32_16x16x32_bf16 v[228:231], v[108:111], a[92:95], v[228:231]
    v_rcp_f32 v43, v43
    v_exp_f32 v39, v39
    v_mfma_f32_16x16x32_bf16 v[228:231], v[100:103], a[124:127], v[228:231]
    v_exp_f32 v32, v32
    v_fma_f32 v24, v24, v40, -v40
    v_fma_f32 v25, v25, v41, -v41
    v_mfma_f32_16x16x32_bf16 v[228:231], v[92:95], a[88:91], v[228:231]
    v_exp_f32 v33, v33
    v_fma_f32 v26, v26, v42, -v42
    v_mfma_f32_16x16x32_bf16 v[228:231], v[84:87], a[120:123], v[228:231]
    v_exp_f32 v34, v34
    v_fma_f32 v27, v27, v43, -v43
    v_cvt_pk_bf16_f32 v44, v24, v25
    v_mfma_f32_16x16x32_bf16 v[228:231], a[184:187], a[84:87], v[228:231]
    v_exp_f32 v35, v35
    v_cvt_pk_bf16_f32 v45, v26, v27
    v_mfma_f32_16x16x32_bf16 v[172:175], a[184:187], a[120:123], v[172:175]
    v_mul_f32 v24, s32, v224
    v_add_f32 v40, 1.0, v32
    v_mul_f32 v25, s32, v225
    v_mfma_f32_16x16x32_bf16 v[172:175], v[84:87], a[88:91], v[172:175]
    ds_read_b128 a[248:251], v9 offset:45056
    v_add_f32 v41, 1.0, v33
    v_mul_f32 v26, s32, v226
    v_mfma_f32_16x16x32_bf16 v[172:175], v[92:95], a[124:127], v[172:175]
    v_add_f32 v42, 1.0, v34
    v_mul_f32 v27, s32, v227
    v_add_f32 v43, 1.0, v35
    v_mfma_f32_16x16x32_bf16 v[172:175], v[100:103], a[92:95], v[172:175]
    v_mul_f32 v28, s33, v228
    v_mul_f32 v29, s33, v229
    v_mfma_f32_16x16x32_bf16 v[172:175], v[108:111], a[128:131], v[172:175]
    v_fma_f32 v40, v40, v36, v40
    v_mul_f32 v30, s33, v230
    v_fma_f32 v41, v41, v37, v41
    v_mfma_f32_16x16x32_bf16 v[172:175], a[204:207], a[168:171], v[172:175]
    v_mul_f32 v31, s33, v231
    v_fma_f32 v42, v42, v38, v42
    v_mfma_f32_16x16x32_bf16 v[172:175], a[212:215], a[172:175], v[172:175]
    v_min_f32 v24, s34, v24
    v_fma_f32 v43, v43, v39, v43
    v_min_f32 v25, s34, v25
    v_mfma_f32_16x16x32_bf16 v[172:175], a[220:223], a[176:179], v[172:175]
    v_min_f32 v26, s34, v26
    v_rcp_f32 v40, v40
    v_mfma_f32_16x16x32_bf16 v[172:175], a[228:231], a[240:243], v[172:175]
    s_waitcnt lgkmcnt(1)
    v_min_f32 v27, s34, v27
    v_exp_f32 v28, v28
    v_mfma_f32_16x16x32_bf16 v[172:175], a[236:239], a[244:247], v[172:175]
    v_rcp_f32 v41, v41
    v_mfma_f32_16x16x32_bf16 v[168:171], a[232:235], a[244:247], v[168:171]
    v_exp_f32 v29, v29
    v_mfma_f32_16x16x32_bf16 v[168:171], a[224:227], a[240:243], v[168:171]
    v_rcp_f32 v42, v42
    v_mfma_f32_16x16x32_bf16 v[168:171], a[216:219], a[176:179], v[168:171]
    v_exp_f32 v30, v30
    v_mfma_f32_16x16x32_bf16 v[168:171], a[208:211], a[172:175], v[168:171]
    v_rcp_f32 v43, v43
    v_mfma_f32_16x16x32_bf16 v[168:171], a[200:203], a[168:171], v[168:171]
    v_exp_f32 v31, v31
    v_mfma_f32_16x16x32_bf16 v[168:171], v[104:107], a[128:131], v[168:171]
    v_exp_f32 v24, v24
    v_fma_f32 v32, v32, v40, -v40
    v_mfma_f32_16x16x32_bf16 v[168:171], v[96:99], a[92:95], v[168:171]
    v_fma_f32 v33, v33, v41, -v41
    v_exp_f32 v25, v25
    v_mfma_f32_16x16x32_bf16 v[168:171], v[88:91], a[124:127], v[168:171]
    v_fma_f32 v34, v34, v42, -v42
    v_exp_f32 v26, v26
    v_mfma_f32_16x16x32_bf16 v[168:171], v[80:83], a[88:91], v[168:171]
    v_fma_f32 v35, v35, v43, -v43
    v_cvt_pk_bf16_f32 v46, v32, v33
    v_mfma_f32_16x16x32_bf16 v[168:171], a[180:183], a[120:123], v[168:171]
    v_exp_f32 v27, v27
    v_cvt_pk_bf16_f32 v47, v34, v35
    v_mfma_f32_16x16x32_bf16 v[232:235], a[180:183], a[88:91], v[232:235]
    s_mov_b32 s63, 8192
    v_permlane16_swap_b32 v44, v46
    v_permlane16_swap_b32 v45, v47
    v_mfma_f32_16x16x32_bf16 v[232:235], v[80:83], a[124:127], v[232:235]
    ds_read_b128 a[136:139], v8 offset:48128
    v_mul_f32 v36, s33, v172
    v_add_f32 v40, 1.0, v24
    v_mfma_f32_16x16x32_bf16 v[232:235], v[88:91], a[92:95], v[232:235]
    ds_read_b128 a[252:255], v9 offset:46080
    v_mul_f32 v37, s33, v173
    v_add_f32 v41, 1.0, v25
    v_mfma_f32_16x16x32_bf16 v[232:235], v[96:99], a[128:131], v[232:235]
    buffer_store_dwordx4 v[44:47], v17, s[12:15], s63 offen
    v_mfma_f32_16x16x32_bf16 v[232:235], v[104:107], a[96:99], v[232:235]
    v_mul_f32 v38, s33, v174
    v_add_f32 v42, 1.0, v26
    v_mul_f32 v39, s33, v175
    v_mfma_f32_16x16x32_bf16 v[232:235], a[200:203], a[172:175], v[232:235]
    v_add_f32 v43, 1.0, v27
    v_mul_f32 v32, s32, v168
    v_mul_f32 v33, s32, v169
    v_mfma_f32_16x16x32_bf16 v[232:235], a[208:211], a[176:179], v[232:235]
    v_fma_f32 v40, v40, v28, v40
    v_mul_f32 v34, s32, v170
    v_fma_f32 v41, v41, v29, v41
    v_mfma_f32_16x16x32_bf16 v[232:235], a[216:219], a[240:243], v[232:235]
    v_mul_f32 v35, s32, v171
    v_fma_f32 v42, v42, v30, v42
    v_min_f32 v32, s34, v32
    v_mfma_f32_16x16x32_bf16 v[232:235], a[224:227], a[244:247], v[232:235]
    s_waitcnt lgkmcnt(2)
    v_fma_f32 v43, v43, v31, v43
    v_min_f32 v33, s34, v33
    v_min_f32 v34, s34, v34
    v_mfma_f32_16x16x32_bf16 v[232:235], a[232:235], a[248:251], v[232:235]
    v_rcp_f32 v40, v40
    v_min_f32 v35, s34, v35
    v_mfma_f32_16x16x32_bf16 v[236:239], a[236:239], a[248:251], v[236:239]
    v_exp_f32 v36, v36
    v_mfma_f32_16x16x32_bf16 v[236:239], a[228:231], a[244:247], v[236:239]
    v_rcp_f32 v41, v41
    v_mfma_f32_16x16x32_bf16 v[236:239], a[220:223], a[240:243], v[236:239]
    v_exp_f32 v37, v37
    v_mfma_f32_16x16x32_bf16 v[236:239], a[212:215], a[176:179], v[236:239]
    v_rcp_f32 v42, v42
    v_mfma_f32_16x16x32_bf16 v[236:239], a[204:207], a[172:175], v[236:239]
    v_exp_f32 v38, v38
    v_mfma_f32_16x16x32_bf16 v[236:239], v[108:111], a[96:99], v[236:239]
    v_rcp_f32 v43, v43
    v_exp_f32 v39, v39
    v_mfma_f32_16x16x32_bf16 v[236:239], v[100:103], a[128:131], v[236:239]
    v_exp_f32 v32, v32
    v_fma_f32 v24, v24, v40, -v40
    v_fma_f32 v25, v25, v41, -v41
    v_mfma_f32_16x16x32_bf16 v[236:239], v[92:95], a[92:95], v[236:239]
    v_exp_f32 v33, v33
    v_fma_f32 v26, v26, v42, -v42
    v_mfma_f32_16x16x32_bf16 v[236:239], v[84:87], a[124:127], v[236:239]
    v_exp_f32 v34, v34
    v_fma_f32 v27, v27, v43, -v43
    v_cvt_pk_bf16_f32 v48, v24, v25
    v_mfma_f32_16x16x32_bf16 v[236:239], a[184:187], a[88:91], v[236:239]
    v_exp_f32 v35, v35
    v_cvt_pk_bf16_f32 v49, v26, v27
    v_mfma_f32_16x16x32_bf16 v[180:183], a[184:187], a[124:127], v[180:183]
    v_mul_f32 v24, s32, v232
    v_add_f32 v40, 1.0, v32
    v_mul_f32 v25, s32, v233
    v_mfma_f32_16x16x32_bf16 v[180:183], v[84:87], a[92:95], v[180:183]
    ds_read_b128 a[140:143], v9 offset:47104
    v_add_f32 v41, 1.0, v33
    v_mul_f32 v26, s32, v234
    v_mfma_f32_16x16x32_bf16 v[180:183], v[92:95], a[128:131], v[180:183]
    v_add_f32 v42, 1.0, v34
    v_mul_f32 v27, s32, v235
    v_add_f32 v43, 1.0, v35
    v_mfma_f32_16x16x32_bf16 v[180:183], v[100:103], a[96:99], v[180:183]
    v_mul_f32 v28, s33, v236
    v_mul_f32 v29, s33, v237
    v_mfma_f32_16x16x32_bf16 v[180:183], v[108:111], a[132:135], v[180:183]
    v_fma_f32 v40, v40, v36, v40
    v_mul_f32 v30, s33, v238
    v_fma_f32 v41, v41, v37, v41
    v_mfma_f32_16x16x32_bf16 v[180:183], a[204:207], a[176:179], v[180:183]
    v_mul_f32 v31, s33, v239
    v_fma_f32 v42, v42, v38, v42
    v_mfma_f32_16x16x32_bf16 v[180:183], a[212:215], a[240:243], v[180:183]
    v_min_f32 v24, s34, v24
    v_fma_f32 v43, v43, v39, v43
    v_min_f32 v25, s34, v25
    v_mfma_f32_16x16x32_bf16 v[180:183], a[220:223], a[244:247], v[180:183]
    v_min_f32 v26, s34, v26
    v_rcp_f32 v40, v40
    v_mfma_f32_16x16x32_bf16 v[180:183], a[228:231], a[248:251], v[180:183]
    s_waitcnt lgkmcnt(1)
    v_min_f32 v27, s34, v27
    v_exp_f32 v28, v28
    v_mfma_f32_16x16x32_bf16 v[180:183], a[236:239], a[252:255], v[180:183]
    v_rcp_f32 v41, v41
    v_mfma_f32_16x16x32_bf16 v[176:179], a[232:235], a[252:255], v[176:179]
    v_exp_f32 v29, v29
    v_mfma_f32_16x16x32_bf16 v[176:179], a[224:227], a[248:251], v[176:179]
    v_rcp_f32 v42, v42
    v_mfma_f32_16x16x32_bf16 v[176:179], a[216:219], a[244:247], v[176:179]
    v_exp_f32 v30, v30
    v_mfma_f32_16x16x32_bf16 v[176:179], a[208:211], a[240:243], v[176:179]
    v_rcp_f32 v43, v43
    v_mfma_f32_16x16x32_bf16 v[176:179], a[200:203], a[176:179], v[176:179]
    v_exp_f32 v31, v31
    v_mfma_f32_16x16x32_bf16 v[176:179], v[104:107], a[132:135], v[176:179]
    v_exp_f32 v24, v24
    v_fma_f32 v32, v32, v40, -v40
    v_mfma_f32_16x16x32_bf16 v[176:179], v[96:99], a[96:99], v[176:179]
    v_fma_f32 v33, v33, v41, -v41
    v_exp_f32 v25, v25
    v_mfma_f32_16x16x32_bf16 v[176:179], v[88:91], a[128:131], v[176:179]
    v_fma_f32 v34, v34, v42, -v42
    v_exp_f32 v26, v26
    v_mfma_f32_16x16x32_bf16 v[176:179], v[80:83], a[92:95], v[176:179]
    v_fma_f32 v35, v35, v43, -v43
    v_cvt_pk_bf16_f32 v50, v32, v33
    v_mfma_f32_16x16x32_bf16 v[176:179], a[180:183], a[124:127], v[176:179]
    v_exp_f32 v27, v27
    v_cvt_pk_bf16_f32 v51, v34, v35
    v_mfma_f32_16x16x32_bf16 v[240:243], a[180:183], a[92:95], v[240:243]
    s_mov_b32 s63, 12288
    v_permlane16_swap_b32 v48, v50
    v_permlane16_swap_b32 v49, v51
    v_mfma_f32_16x16x32_bf16 v[240:243], v[80:83], a[128:131], v[240:243]
    ds_read_b128 a[144:147], v9 offset:48128
    v_mul_f32 v36, s33, v180
    v_add_f32 v40, 1.0, v24
    v_mfma_f32_16x16x32_bf16 v[240:243], v[88:91], a[96:99], v[240:243]
    buffer_store_dwordx4 v[48:51], v17, s[12:15], s63 offen
    v_mfma_f32_16x16x32_bf16 v[240:243], v[96:99], a[132:135], v[240:243]
    v_mul_f32 v37, s33, v181
    v_add_f32 v41, 1.0, v25
    v_mul_f32 v38, s33, v182
    v_mfma_f32_16x16x32_bf16 v[240:243], v[104:107], a[100:103], v[240:243]
    v_add_f32 v42, 1.0, v26
    v_mul_f32 v39, s33, v183
    v_add_f32 v43, 1.0, v27
    v_mfma_f32_16x16x32_bf16 v[240:243], a[200:203], a[240:243], v[240:243]
    v_mul_f32 v32, s32, v176
    v_mul_f32 v33, s32, v177
    v_fma_f32 v40, v40, v28, v40
    v_mfma_f32_16x16x32_bf16 v[240:243], a[208:211], a[244:247], v[240:243]
    v_mul_f32 v34, s32, v178
    v_fma_f32 v41, v41, v29, v41
    v_mul_f32 v35, s32, v179
    v_mfma_f32_16x16x32_bf16 v[240:243], a[216:219], a[248:251], v[240:243]
    v_fma_f32 v42, v42, v30, v42
    v_min_f32 v32, s34, v32
    v_fma_f32 v43, v43, v31, v43
    v_mfma_f32_16x16x32_bf16 v[240:243], a[224:227], a[252:255], v[240:243]
    s_waitcnt lgkmcnt(1)
    v_min_f32 v33, s34, v33
    v_min_f32 v34, s34, v34
    v_mfma_f32_16x16x32_bf16 v[240:243], a[232:235], a[140:143], v[240:243]
    v_rcp_f32 v40, v40
    v_min_f32 v35, s34, v35
    v_mfma_f32_16x16x32_bf16 v[244:247], a[236:239], a[140:143], v[244:247]
    v_exp_f32 v36, v36
    v_mfma_f32_16x16x32_bf16 v[244:247], a[228:231], a[252:255], v[244:247]
    v_rcp_f32 v41, v41
    v_mfma_f32_16x16x32_bf16 v[244:247], a[220:223], a[248:251], v[244:247]
    v_exp_f32 v37, v37
    v_mfma_f32_16x16x32_bf16 v[244:247], a[212:215], a[244:247], v[244:247]
    v_rcp_f32 v42, v42
    v_mfma_f32_16x16x32_bf16 v[244:247], a[204:207], a[240:243], v[244:247]
    v_exp_f32 v38, v38
    v_mfma_f32_16x16x32_bf16 v[244:247], v[108:111], a[100:103], v[244:247]
    v_rcp_f32 v43, v43
    v_exp_f32 v39, v39
    v_mfma_f32_16x16x32_bf16 v[244:247], v[100:103], a[132:135], v[244:247]
    v_exp_f32 v32, v32
    v_fma_f32 v24, v24, v40, -v40
    v_fma_f32 v25, v25, v41, -v41
    v_mfma_f32_16x16x32_bf16 v[244:247], v[92:95], a[96:99], v[244:247]
    v_exp_f32 v33, v33
    v_fma_f32 v26, v26, v42, -v42
    v_mfma_f32_16x16x32_bf16 v[244:247], v[84:87], a[128:131], v[244:247]
    v_exp_f32 v34, v34
    v_fma_f32 v27, v27, v43, -v43
    v_cvt_pk_bf16_f32 v44, v24, v25
    v_mfma_f32_16x16x32_bf16 v[244:247], a[184:187], a[92:95], v[244:247]
    v_exp_f32 v35, v35
    v_cvt_pk_bf16_f32 v45, v26, v27
    v_mfma_f32_16x16x32_bf16 v[188:191], a[184:187], a[128:131], v[188:191]
    v_mul_f32 v24, s32, v240
    v_add_f32 v40, 1.0, v32
    v_mul_f32 v25, s32, v241
    v_mfma_f32_16x16x32_bf16 v[188:191], v[84:87], a[96:99], v[188:191]
    v_add_f32 v41, 1.0, v33
    v_mul_f32 v26, s32, v242
    v_mfma_f32_16x16x32_bf16 v[188:191], v[92:95], a[132:135], v[188:191]
    v_add_f32 v42, 1.0, v34
    v_mul_f32 v27, s32, v243
    v_add_f32 v43, 1.0, v35
    v_mfma_f32_16x16x32_bf16 v[188:191], v[100:103], a[100:103], v[188:191]
    v_mul_f32 v28, s33, v244
    v_mul_f32 v29, s33, v245
    v_mfma_f32_16x16x32_bf16 v[188:191], v[108:111], a[136:139], v[188:191]
    v_fma_f32 v40, v40, v36, v40
    v_mul_f32 v30, s33, v246
    v_fma_f32 v41, v41, v37, v41
    v_mfma_f32_16x16x32_bf16 v[188:191], a[204:207], a[244:247], v[188:191]
    v_mul_f32 v31, s33, v247
    v_fma_f32 v42, v42, v38, v42
    v_mfma_f32_16x16x32_bf16 v[188:191], a[212:215], a[248:251], v[188:191]
    v_min_f32 v24, s34, v24
    v_fma_f32 v43, v43, v39, v43
    v_min_f32 v25, s34, v25
    v_mfma_f32_16x16x32_bf16 v[188:191], a[220:223], a[252:255], v[188:191]
    v_min_f32 v26, s34, v26
    v_rcp_f32 v40, v40
    v_mfma_f32_16x16x32_bf16 v[188:191], a[228:231], a[140:143], v[188:191]
    s_waitcnt lgkmcnt(0)
    v_min_f32 v27, s34, v27
    v_exp_f32 v28, v28
    v_mfma_f32_16x16x32_bf16 v[188:191], a[236:239], a[144:147], v[188:191]
    v_rcp_f32 v41, v41
    v_mfma_f32_16x16x32_bf16 v[184:187], a[232:235], a[144:147], v[184:187]
    v_exp_f32 v29, v29
    v_mfma_f32_16x16x32_bf16 v[184:187], a[224:227], a[140:143], v[184:187]
    v_rcp_f32 v42, v42
    v_mfma_f32_16x16x32_bf16 v[184:187], a[216:219], a[252:255], v[184:187]
    v_exp_f32 v30, v30
    v_mfma_f32_16x16x32_bf16 v[184:187], a[208:211], a[248:251], v[184:187]
    v_rcp_f32 v43, v43
    v_mfma_f32_16x16x32_bf16 v[184:187], a[200:203], a[244:247], v[184:187]
    v_exp_f32 v31, v31
    v_mfma_f32_16x16x32_bf16 v[184:187], v[104:107], a[136:139], v[184:187]
    v_exp_f32 v24, v24
    v_fma_f32 v32, v32, v40, -v40
    v_mfma_f32_16x16x32_bf16 v[184:187], v[96:99], a[100:103], v[184:187]
    v_fma_f32 v33, v33, v41, -v41
    v_exp_f32 v25, v25
    v_mfma_f32_16x16x32_bf16 v[184:187], v[88:91], a[132:135], v[184:187]
    v_fma_f32 v34, v34, v42, -v42
    v_exp_f32 v26, v26
    v_mfma_f32_16x16x32_bf16 v[184:187], v[80:83], a[96:99], v[184:187]
    v_fma_f32 v35, v35, v43, -v43
    v_cvt_pk_bf16_f32 v46, v32, v33
    v_mfma_f32_16x16x32_bf16 v[184:187], a[180:183], a[128:131], v[184:187]
    v_exp_f32 v27, v27
    v_cvt_pk_bf16_f32 v47, v34, v35
    s_mov_b32 s63, 16384
    s_nop 0
    v_permlane16_swap_b32 v44, v46
    v_permlane16_swap_b32 v45, v47
    buffer_store_dwordx4 v[44:47], v17, s[12:15], s63 offen
    v_mul_f32 v36, s33, v188
    v_add_f32 v40, 1.0, v24
    v_mul_f32 v37, s33, v189
    v_add_f32 v41, 1.0, v25
    v_mul_f32 v38, s33, v190
    v_add_f32 v42, 1.0, v26
    v_mul_f32 v39, s33, v191
    v_add_f32 v43, 1.0, v27
    v_mul_f32 v32, s32, v184
    v_mul_f32 v33, s32, v185
    v_fma_f32 v40, v40, v28, v40
    v_mul_f32 v34, s32, v186
    v_fma_f32 v41, v41, v29, v41
    v_mul_f32 v35, s32, v187
    v_fma_f32 v42, v42, v30, v42
    v_min_f32 v32, s34, v32
    v_fma_f32 v43, v43, v31, v43
    v_min_f32 v33, s34, v33
    v_min_f32 v34, s34, v34
    v_rcp_f32 v40, v40
    v_min_f32 v35, s34, v35
    v_exp_f32 v36, v36
    v_rcp_f32 v41, v41
    v_exp_f32 v37, v37
    v_rcp_f32 v42, v42
    v_exp_f32 v38, v38
    v_rcp_f32 v43, v43
    v_exp_f32 v39, v39
    v_exp_f32 v32, v32
    v_fma_f32 v24, v24, v40, -v40
    v_fma_f32 v25, v25, v41, -v41
    v_exp_f32 v33, v33
    v_fma_f32 v26, v26, v42, -v42
    v_exp_f32 v34, v34
    v_fma_f32 v27, v27, v43, -v43
    v_cvt_pk_bf16_f32 v48, v24, v25
    v_exp_f32 v35, v35
    v_cvt_pk_bf16_f32 v49, v26, v27
    v_add_f32 v40, 1.0, v32
    v_add_f32 v41, 1.0, v33
    v_add_f32 v42, 1.0, v34
    v_add_f32 v43, 1.0, v35
    v_fma_f32 v40, v40, v36, v40
    v_fma_f32 v41, v41, v37, v41
    v_fma_f32 v42, v42, v38, v42
    v_fma_f32 v43, v43, v39, v43
    v_rcp_f32 v40, v40
    v_rcp_f32 v41, v41
    v_rcp_f32 v42, v42
    v_rcp_f32 v43, v43
    v_fma_f32 v32, v32, v40, -v40
    v_fma_f32 v33, v33, v41, -v41
    v_fma_f32 v34, v34, v42, -v42
    v_fma_f32 v35, v35, v43, -v43
    v_cvt_pk_bf16_f32 v50, v32, v33
    v_cvt_pk_bf16_f32 v51, v34, v35
    s_mov_b32 s63, 20480
    s_nop 0
    v_permlane16_swap_b32 v48, v50
    v_permlane16_swap_b32 v49, v51
    buffer_store_dwordx4 v[48:51], v18, s[12:15], s63 offen
L_end:
    s_endpgm

.section .rodata,"a"
.p2align 6
.amdhsa_kernel standalone__autoregressive_conv_wavernn__speech_kernel
  .amdhsa_next_free_vgpr 512
  .amdhsa_next_free_sgpr 102
  .amdhsa_accum_offset 256
  .amdhsa_group_segment_fixed_size 0
  .amdhsa_kernarg_size 40
  .amdhsa_user_sgpr_count 2
  .amdhsa_user_sgpr_kernarg_segment_ptr 1
  .amdhsa_system_sgpr_workgroup_id_x 1
.end_amdhsa_kernel
```
